```python
import torch

def _softmax(x, axis=-1):
    return torch.softmax(x, dim=axis)
def _gelu(x):
    return torch.nn.functional.gelu(x, approximate="tanh")
def _silu(x):
    return torch.nn.functional.silu(x)
def _sigmoid(x):
    return torch.sigmoid(x)
def _layernorm(x, axis=-1, eps=1e-5):
    m = x.mean(dim=axis, keepdim=True)
    v = x.var(dim=axis, keepdim=True, unbiased=False)
    return (x - m) / torch.sqrt(v + eps)
def _scatter_add(tgt, idx, src, axis=0):
    return tgt.clone().index_add_(axis, idx, src)
def _segment_sum(src, seg, n):
    out = torch.zeros((n,) + src.shape[1:], dtype=src.dtype)
    return out.index_add_(0, seg, src)
def _pad(x, pw):
    flat = tuple(v for pair in reversed(pw) for v in pair)
    return torch.nn.functional.pad(x, flat)

kernel_name = 'concat_heads__softmax_full_mha__mha_block__prompt'

def setup_inputs():

    _w = (lambda a: (lambda t: t.to(torch.bfloat16) if t.is_floating_point() else t)(torch.as_tensor(a)))
    def _A_setup():
        B, S, D = 1, 2048, 448
        return {
            "x": _w((lambda *s: torch.randn(*s, dtype=torch.bfloat16) * 0.2)(B, S, D)),
            "wqkv": _w((lambda *s: torch.randn(*s, dtype=torch.bfloat16) * 0.2)(D, 3 * D)),
            "wo": _w((lambda *s: torch.randn(*s, dtype=torch.bfloat16) * 0.05)(D, D)),
        }
    _A_in = _A_setup()

    def _B_setup():
        B, S, D, H = 1, 2048, 448, 16
        return {
            "x": _w((lambda *s: torch.randn(*s, dtype=torch.bfloat16) * 0.2)(B, S, D)),
            "wqkv": _w((lambda *s: torch.randn(*s, dtype=torch.bfloat16) * 0.2)(D, 3 * D)),
            "wo": _w((lambda *s: torch.randn(*s, dtype=torch.bfloat16) * 0.05)(D, D)),
        }
    _B_in = _B_setup()

    return {
        "A_x": _A_in["x"],
        "A_wqkv": _A_in["wqkv"],
        "A_wo": _A_in["wo"],
        "B_x": _B_in["x"],
        "B_wqkv": _B_in["wqkv"],
        "B_wo": _B_in["wo"],
    }

def reference(A_x, A_wqkv, A_wo, B_x, B_wqkv, B_wo):
    def _A_ref(x, wqkv, wo):
        B, S, D = x.shape
        H = 16; Dh = D // H
        qkv = (lambda x, *d: x.permute(*d))((x @ wqkv).reshape(B, S, 3, H, Dh), 2, 0, 3, 1, 4)
        q, k, v = qkv[0], qkv[1], qkv[2]
        scale = Dh ** -0.5
        scores = torch.einsum("bhqd,bhkd->bhqk", q, k) * scale
        p = _softmax(scores, axis=-1)
        o = torch.einsum("bhqk,bhkd->bhqd", p, v)
        return (lambda x, *d: x.permute(*d))(o, 0, 2, 1, 3).reshape(B, S, D) @ wo

    def _B_ref(x, wqkv, wo):
        B, S, D = x.shape
        H = 16
        Dh = D // H
        qkv = (lambda x, *d: x.permute(*d))((x @ wqkv).reshape(B, S, 3, H, Dh), 2, 0, 3, 1, 4)
        q, k, v = qkv[0], qkv[1], qkv[2]
        scores = torch.einsum("bhqd,bhkd->bhqk", q, k) * (Dh ** -0.5)
        p = _softmax(scores, axis=-1)
        o = torch.einsum("bhqk,bhkd->bhqd", p, v)
        return (lambda x, *d: x.permute(*d))(o, 0, 2, 1, 3).reshape(B, S, D) @ wo

    a = _A_ref(A_x, A_wqkv, A_wo)
    b = _B_ref(B_x, B_wqkv, B_wo)
    return torch.concatenate([a, b], axis=-1)
```

```asm
; @launch grid=(256,1,1) block=(512,1,1) lds=163840
.amdgcn_target "amdgcn-amd-amdhsa--gfx950"
.text
.globl concat_heads__softmax_full_mha__mha_block__prompt_kernel
.p2align 8
.type concat_heads__softmax_full_mha__mha_block__prompt_kernel,@function
concat_heads__softmax_full_mha__mha_block__prompt_kernel:
    s_cmp_ge_u32 s2, 256
    s_cbranch_scc1 L_end
    s_load_dwordx16 s[4:19], s[0:1], 0
    s_load_dwordx2 s[20:21], s[0:1], 64
    s_and_b32 s22, s2, 7
    s_lshr_b32 s23, s2, 3
    s_lshr_b32 s24, s22, 2
    s_bfe_u32 s25, s22, 0x10001
    s_lshl_b32 s25, s25, 3
    s_and_b32 s53, s23, 7
    s_add_u32 s25, s25, s53
    s_and_b32 s26, s22, 1
    s_lshl_b32 s26, s26, 2
    s_lshr_b32 s54, s23, 3
    s_add_u32 s26, s26, s54
    s_add_u32 s54, s54, s23
    s_and_b32 s54, s54, 3
    s_lshl_b32 s54, s54, 1
    v_lshrrev_b32 v1, 6, v0
    v_and_b32 v2, 63, v0
    v_mov_b32 v7, 0
    v_readfirstlane_b32 s27, v1
    v_lshlrev_b32 v3, 4, v2
    s_and_b32 s48, s27, 3
    s_lshr_b32 s49, s27, 2
    s_cmp_eq_u32 s49, 0
    s_cbranch_scc1 L_compute
    v_lshrrev_b32 v8, 3, v2
    v_and_b32 v9, 7, v2
    v_lshrrev_b32 v14, 4, v2
    v_xor_b32 v9, v9, v14
    v_xor_b32 v14, 4, v9
    s_lshl_b32 s55, s25, 7
    s_lshl_b32 s56, s48, 5
    s_add_u32 s55, s55, s56
    s_mul_i32 s55, s55, 896
    v_mul_u32_u24 v8, 896, v8
    v_add_u32 v8, s55, v8
    v_lshl_add_u32 v10, v9, 4, v8
    v_lshl_add_u32 v11, v14, 4, v8
    v_add_u32 v12, 12288, v10
    v_add_u32 v13, 18432, v11
    v_add_u32 v11, 6144, v11
    s_lshl_b32 s55, s48, 12
    s_lshl_b32 s57, s54, 7
    s_mov_b32 m0, s55
    s_mul_i32 s58, s54, 172032
    s_mov_b32 s30, 1835008
    s_mov_b32 s31, 0x20000
    s_mov_b32 s34, 1204224
    s_mov_b32 s35, 0x20000
    v_lshrrev_b32 v8, 4, v2
    v_and_b32 v9, 15, v2
    v_lshlrev_b32 v20, 2, v8
    v_xor_b32 v9, v9, v20
    v_lshrrev_b32 v20, 3, v9
    v_and_b32 v9, 7, v9
    v_add_u32 v21, 1, v9
    v_lshlrev_b32 v21, 27, v21
    v_and_b32 v21, 0x40000000, v21
    v_mul_u32_u24 v8, 2688, v8
    v_mul_u32_u24 v20, 896, v20
    v_lshl_add_u32 v9, v9, 4, v21
    v_add3_u32 v8, v8, v9, v20
    s_mul_i32 s59, s48, 43008
    s_mul_i32 s60, s26, 112
    s_add_u32 s59, s59, s60
    s_add_u32 s60, s59, 896
    v_add_u32 v14, s60, v8
    v_add_u32 v15, 9728, v14
    v_add_u32 v16, 19456, v14
    v_add_u32 v17, 29184, v14
    s_waitcnt lgkmcnt(0)
    s_cmp_eq_u32 s24, 0
    s_cselect_b32 s28, s4, s10
    s_cselect_b32 s29, s5, s11
    s_cselect_b32 s32, s6, s12
    s_cselect_b32 s33, s7, s13
    buffer_load_dwordx4 v10, s[28:31], s57 offen offset:0 sc1 lds
    buffer_load_dwordx4 v11, s[28:31], s57 offen offset:1024 sc1 lds
    buffer_load_dwordx4 v12, s[28:31], s57 offen offset:2048 sc1 lds
    buffer_load_dwordx4 v13, s[28:31], s57 offen offset:3072 sc1 lds
    s_add_u32 m0, s55, 147456
    s_nop 0
    buffer_load_dwordx4 v14, s[32:35], s58 offen offset:0 sc1 lds
    buffer_load_dwordx4 v15, s[32:35], s58 offen offset:1024 sc1 lds
    buffer_load_dwordx4 v16, s[32:35], s58 offen offset:2048 sc1 lds
    buffer_load_dwordx4 v17, s[32:35], s58 offen offset:3072 sc1 lds
    s_add_u32 s54, s54, 1
    s_cmp_eq_u32 s54, 7
    s_cselect_b32 s54, 0, s54
    s_lshl_b32 s57, s54, 7
    s_add_u32 m0, s55, 16384
    s_mul_i32 s58, s54, 172032
    buffer_load_dwordx4 v10, s[28:31], s57 offen offset:0 sc1 lds
    buffer_load_dwordx4 v11, s[28:31], s57 offen offset:1024 sc1 lds
    buffer_load_dwordx4 v12, s[28:31], s57 offen offset:2048 sc1 lds
    buffer_load_dwordx4 v13, s[28:31], s57 offen offset:3072 sc1 lds
    s_add_u32 m0, s55, 114688
    s_nop 0
    buffer_load_dwordx4 v14, s[32:35], s58 offen offset:0 sc1 lds
    buffer_load_dwordx4 v15, s[32:35], s58 offen offset:1024 sc1 lds
    buffer_load_dwordx4 v16, s[32:35], s58 offen offset:2048 sc1 lds
    buffer_load_dwordx4 v17, s[32:35], s58 offen offset:3072 sc1 lds
    s_add_u32 s54, s54, 1
    s_cmp_eq_u32 s54, 7
    s_cselect_b32 s54, 0, s54
    v_lshrrev_b32 v8, 3, v2
    v_and_b32 v9, 7, v2
    v_bfe_u32 v20, v2, 4, 1
    v_lshlrev_b32 v20, 2, v20
    v_xor_b32 v9, v9, v20
    v_add_u32 v21, 1, v9
    v_lshlrev_b32 v21, 27, v21
    v_and_b32 v21, 0x40000000, v21
    v_mul_u32_u24 v8, 2688, v8
    v_lshl_add_u32 v8, v9, 4, v8
    v_add_u32 v8, v8, v21
    v_add_u32 v18, s59, v8
    v_add_u32 v19, 20480, v18
    s_lshl_b32 s56, s48, 11
    s_waitcnt vmcnt(8)
    s_barrier
    s_lshl_b32 s57, s54, 7
    s_add_u32 m0, s55, 32768
    s_mul_i32 s58, s54, 172032
    buffer_load_dwordx4 v10, s[28:31], s57 offen offset:0 sc1 lds
    buffer_load_dwordx4 v11, s[28:31], s57 offen offset:1024 sc1 lds
    buffer_load_dwordx4 v12, s[28:31], s57 offen offset:2048 sc1 lds
    buffer_load_dwordx4 v13, s[28:31], s57 offen offset:3072 sc1 lds
    s_add_u32 m0, s55, 131072
    s_nop 0
    buffer_load_dwordx4 v14, s[32:35], s58 offen offset:0 sc1 lds
    buffer_load_dwordx4 v15, s[32:35], s58 offen offset:1024 sc1 lds
    buffer_load_dwordx4 v16, s[32:35], s58 offen offset:2048 sc1 lds
    buffer_load_dwordx4 v17, s[32:35], s58 offen offset:3072 sc1 lds
    s_add_u32 s54, s54, 1
    s_cmp_eq_u32 s54, 7
    s_cselect_b32 s54, 0, s54
    s_waitcnt vmcnt(8)
    s_barrier
    s_lshl_b32 s57, s54, 7
    s_add_u32 m0, s55, 49152
    s_mul_i32 s58, s54, 172032
    buffer_load_dwordx4 v10, s[28:31], s57 offen offset:0 sc1 lds
    buffer_load_dwordx4 v11, s[28:31], s57 offen offset:1024 sc1 lds
    buffer_load_dwordx4 v12, s[28:31], s57 offen offset:2048 sc1 lds
    buffer_load_dwordx4 v13, s[28:31], s57 offen offset:3072 sc1 lds
    s_add_u32 m0, s55, 147456
    s_nop 0
    buffer_load_dwordx4 v14, s[32:35], s58 offen offset:0 sc1 lds
    buffer_load_dwordx4 v15, s[32:35], s58 offen offset:1024 sc1 lds
    buffer_load_dwordx4 v16, s[32:35], s58 offen offset:2048 sc1 lds
    buffer_load_dwordx4 v17, s[32:35], s58 offen offset:3072 sc1 lds
    s_add_u32 s54, s54, 1
    s_cmp_eq_u32 s54, 7
    s_cselect_b32 s54, 0, s54
    s_waitcnt vmcnt(8)
    s_barrier
    s_lshl_b32 s57, s54, 7
    s_add_u32 m0, s55, 65536
    s_mul_i32 s58, s54, 172032
    buffer_load_dwordx4 v10, s[28:31], s57 offen offset:0 sc1 lds
    buffer_load_dwordx4 v11, s[28:31], s57 offen offset:1024 sc1 lds
    buffer_load_dwordx4 v12, s[28:31], s57 offen offset:2048 sc1 lds
    buffer_load_dwordx4 v13, s[28:31], s57 offen offset:3072 sc1 lds
    s_add_u32 m0, s55, 114688
    s_nop 0
    buffer_load_dwordx4 v14, s[32:35], s58 offen offset:0 sc1 lds
    buffer_load_dwordx4 v15, s[32:35], s58 offen offset:1024 sc1 lds
    buffer_load_dwordx4 v16, s[32:35], s58 offen offset:2048 sc1 lds
    buffer_load_dwordx4 v17, s[32:35], s58 offen offset:3072 sc1 lds
    s_add_u32 s54, s54, 1
    s_cmp_eq_u32 s54, 7
    s_cselect_b32 s54, 0, s54
    s_waitcnt vmcnt(8)
    s_barrier
    s_lshl_b32 s57, s54, 7
    s_add_u32 m0, s55, 81920
    s_mul_i32 s58, s54, 172032
    buffer_load_dwordx4 v10, s[28:31], s57 offen offset:0 sc1 lds
    buffer_load_dwordx4 v11, s[28:31], s57 offen offset:1024 sc1 lds
    buffer_load_dwordx4 v12, s[28:31], s57 offen offset:2048 sc1 lds
    buffer_load_dwordx4 v13, s[28:31], s57 offen offset:3072 sc1 lds
    s_add_u32 m0, s55, 131072
    s_nop 0
    buffer_load_dwordx4 v14, s[32:35], s58 offen offset:0 sc1 lds
    buffer_load_dwordx4 v15, s[32:35], s58 offen offset:1024 sc1 lds
    buffer_load_dwordx4 v16, s[32:35], s58 offen offset:2048 sc1 lds
    buffer_load_dwordx4 v17, s[32:35], s58 offen offset:3072 sc1 lds
    s_add_u32 s54, s54, 1
    s_cmp_eq_u32 s54, 7
    s_cselect_b32 s54, 0, s54
    s_waitcnt vmcnt(8)
    s_barrier
    s_lshl_b32 s57, s54, 7
    s_add_u32 m0, s55, 98304
    s_mul_i32 s58, s54, 172032
    buffer_load_dwordx4 v10, s[28:31], s57 offen offset:0 sc1 lds
    buffer_load_dwordx4 v11, s[28:31], s57 offen offset:1024 sc1 lds
    buffer_load_dwordx4 v12, s[28:31], s57 offen offset:2048 sc1 lds
    buffer_load_dwordx4 v13, s[28:31], s57 offen offset:3072 sc1 lds
    s_add_u32 m0, s55, 147456
    s_nop 0
    buffer_load_dwordx4 v14, s[32:35], s58 offen offset:0 sc1 lds
    buffer_load_dwordx4 v15, s[32:35], s58 offen offset:1024 sc1 lds
    buffer_load_dwordx4 v16, s[32:35], s58 offen offset:2048 sc1 lds
    buffer_load_dwordx4 v17, s[32:35], s58 offen offset:3072 sc1 lds
    s_add_u32 s54, s54, 1
    s_cmp_eq_u32 s54, 7
    s_cselect_b32 s54, 0, s54
    s_waitcnt vmcnt(8)
    s_barrier
    s_add_u32 m0, s56, 114688
    s_mul_i32 s58, s54, 172032
    buffer_load_dwordx4 v18, s[32:35], s58 offen offset:0 sc1 lds
    buffer_load_dwordx4 v19, s[32:35], s58 offen offset:1024 sc1 lds
    s_add_u32 s54, s54, 1
    s_cmp_eq_u32 s54, 7
    s_cselect_b32 s54, 0, s54
    s_add_u32 m0, s56, 122880
    s_mul_i32 s58, s54, 172032
    buffer_load_dwordx4 v18, s[32:35], s58 offen offset:0 sc1 lds
    buffer_load_dwordx4 v19, s[32:35], s58 offen offset:1024 sc1 lds
    s_add_u32 s54, s54, 1
    s_cmp_eq_u32 s54, 7
    s_cselect_b32 s54, 0, s54
    s_waitcnt vmcnt(4)
    s_barrier
    s_add_u32 m0, s56, 131072
    s_mul_i32 s58, s54, 172032
    buffer_load_dwordx4 v18, s[32:35], s58 offen offset:0 sc1 lds
    buffer_load_dwordx4 v19, s[32:35], s58 offen offset:1024 sc1 lds
    s_add_u32 s54, s54, 1
    s_cmp_eq_u32 s54, 7
    s_cselect_b32 s54, 0, s54
    s_add_u32 m0, s56, 139264
    s_mul_i32 s58, s54, 172032
    buffer_load_dwordx4 v18, s[32:35], s58 offen offset:0 sc1 lds
    buffer_load_dwordx4 v19, s[32:35], s58 offen offset:1024 sc1 lds
    s_add_u32 s54, s54, 1
    s_cmp_eq_u32 s54, 7
    s_cselect_b32 s54, 0, s54
    s_waitcnt vmcnt(4)
    s_barrier
    s_add_u32 m0, s56, 147456
    s_mul_i32 s58, s54, 172032
    buffer_load_dwordx4 v18, s[32:35], s58 offen offset:0 sc1 lds
    buffer_load_dwordx4 v19, s[32:35], s58 offen offset:1024 sc1 lds
    s_add_u32 s54, s54, 1
    s_cmp_eq_u32 s54, 7
    s_cselect_b32 s54, 0, s54
    s_add_u32 m0, s56, 155648
    s_mul_i32 s58, s54, 172032
    buffer_load_dwordx4 v18, s[32:35], s58 offen offset:0 sc1 lds
    buffer_load_dwordx4 v19, s[32:35], s58 offen offset:1024 sc1 lds
    s_add_u32 s54, s54, 1
    s_cmp_eq_u32 s54, 7
    s_cselect_b32 s54, 0, s54
    s_waitcnt vmcnt(4)
    s_barrier
    s_add_u32 m0, s56, 114688
    s_mul_i32 s58, s54, 172032
    buffer_load_dwordx4 v18, s[32:35], s58 offen offset:0 sc1 lds
    buffer_load_dwordx4 v19, s[32:35], s58 offen offset:1024 sc1 lds
    s_add_u32 s54, s54, 1
    s_cmp_eq_u32 s54, 7
    s_cselect_b32 s54, 0, s54
    s_cmp_eq_u32 s24, 0
    s_mov_b32 s36, s20
    s_mov_b32 s37, s21
    s_mov_b32 s38, 13631488
    s_mov_b32 s39, 0x20000
    s_cselect_b32 s40, s8, s14
    s_cselect_b32 s41, s9, s15
    s_mov_b32 s42, 401408
    s_mov_b32 s43, 0x20000
    s_mov_b32 s44, s16
    s_mov_b32 s45, s17
    s_mov_b32 s46, 3670016
    s_mov_b32 s47, 0x20000
    v_mov_b32 v4, 0xdddddddd
    s_lshl_b32 s62, s24, 3
    s_add_u32 s62, s62, s26
    s_lshl_b32 s9, s62, 9
    s_add_u32 s9, s9, 12582912
    s_lshl_b32 s63, s48, 7
    s_add_u32 s10, s9, s63
    s_lshl_b32 s63, s25, 3
    s_add_u32 s10, s10, s63
    s_and_b32 s63, s48, 2
    s_add_u32 s63, s63, s49
    s_lshl_b32 s63, s63, 7
    s_add_u32 s9, s9, s63
    s_lshl_b32 s62, s62, 1
    s_lshr_b32 s101, s48, 1
    s_add_u32 s52, s62, s101
    s_and_b32 s100, s48, 1
    s_lshl_b32 s63, s49, 1
    s_add_u32 s100, s100, s63
    s_lshl_b32 s4, s52, 6
    s_add_u32 s4, s4, s100
    s_lshl_b32 s4, s4, 12
    s_lshl_b32 s62, s101, 14
    s_lshl_b32 s63, s100, 12
    s_add_u32 s63, s63, s62
    s_add_u32 s63, s63, 131072
    v_add_u32 v5, s63, v3
    s_mul_i32 s62, s101, 24576
    s_add_u32 s62, s62, 65536
    v_add_u32 v243, s62, v3
    s_lshl_b32 s8, s100, 12
    s_mul_i32 s7, s49, 49152
    s_and_b32 s63, s48, 1
    s_mul_i32 s63, s63, 12288
    s_add_u32 s7, s7, s63
    s_add_u32 s7, s7, 65536
    s_lshl_b32 s62, s101, 13
    s_add_u32 s62, s62, 65536
    v_add_u32 v6, s62, v3
    v_lshlrev_b32 v240, 3, v2
    v_mov_b32 v248, v240
    s_mul_i32 s62, s23, 37
    s_lshr_b32 s62, s62, 8
    s_mul_i32 s3, s62, 7
    s_sub_u32 s3, s23, s3
    s_lshl_b32 s12, s22, 2
    s_add_u32 s12, s12, s62
    s_lshl_b32 s12, s12, 2
    s_add_u32 s12, s12, s100
    v_lshrrev_b32 v241, 3, v2
    v_and_b32 v244, 7, v2
    v_bfe_u32 v245, v2, 4, 1
    v_lshlrev_b32 v245, 2, v245
    v_xor_b32 v244, v244, v245
    v_mul_u32_u24 v241, 896, v241
    v_lshl_add_u32 v241, v244, 4, v241
    s_mul_i32 s62, s27, 7168
    s_lshl_b32 s63, s3, 7
    s_add_u32 s62, s62, s63
    v_add_u32 v241, s62, v241
    s_lshl_b32 s13, s27, 10
    s_mov_b32 s11, 0
    s_lshl_b32 s62, s24, 4
    s_add_u32 s62, s62, s25
    s_lshl_b32 s62, s62, 2
    s_add_u32 s62, s62, s100
    s_lshl_b32 s62, s62, 4
    s_and_b32 s63, s52, 15
    s_add_u32 s62, s62, s63
    s_lshl_b32 s15, s62, 3
    s_add_u32 s15, s15, 12845056
    s_lshl_b32 s14, s62, 11
    s_add_u32 s14, s14, 8388608
    s_lshl_b32 s16, s12, 7
    s_lshl_b32 s62, s101, 6
    s_add_u32 s16, s16, s62
    s_add_u32 s16, s16, 12845056
    s_lshl_b32 s17, s12, 15
    s_lshl_b32 s62, s101, 14
    s_add_u32 s17, s17, s62
    s_add_u32 s17, s17, 8388608
    v_lshrrev_b32 v252, 5, v2
    v_bfe_u32 v253, v2, 2, 2
    v_lshl_add_u32 v244, v252, 2, v253
    v_lshlrev_b32 v244, 7, v244
    v_bfe_u32 v253, v2, 4, 1
    v_lshl_add_u32 v244, v253, 5, v244
    v_and_b32 v253, 3, v2
    v_lshl_add_u32 v244, v253, 3, v244
    v_bfe_u32 v253, v2, 3, 1
    v_lshl_add_u32 v244, v253, 6, v244
    s_mul_i32 s62, s101, 28672
    v_add_u32 v244, s62, v244
    v_and_b32 v253, 31, v2
    v_and_b32 v254, 7, v2
    v_xor_b32 v255, v252, v254
    v_lshlrev_b32 v255, 4, v255
    v_lshl_add_u32 v246, v253, 8, v255
    s_mul_i32 s62, s101, 24576
    s_add_u32 s62, s62, s7
    v_add_u32 v246, s62, v246
    v_lshrrev_b32 v253, 3, v2
    v_lshlrev_b32 v255, 1, v254
    v_xor_b32 v255, v255, v253
    v_lshlrev_b32 v255, 4, v255
    v_lshl_add_u32 v247, v253, 8, v255
    s_lshl_b32 s62, s101, 12
    s_add_u32 s62, s62, s7
    v_add_u32 v247, s62, v247
    s_and_b32 s62, s12, 63
    s_lshl_b32 s62, s62, 5
    s_lshl_b32 s63, s101, 4
    s_add_u32 s62, s62, s63
    v_add_u32 v253, s62, v253
    v_mul_u32_u24 v253, 1792, v253
    v_lshl_add_u32 v245, v254, 4, v253
    s_mul_i32 s62, s24, 896
    s_lshl_b32 s63, s3, 7
    s_add_u32 s62, s62, s63
    v_add_u32 v245, s62, v245
    s_mov_b32 s68, 0
    v_mov_b32 v176, 0
    v_mov_b32 v177, 0
    v_mov_b32 v178, 0
    v_mov_b32 v179, 0
    v_mov_b32 v180, 0
    v_mov_b32 v181, 0
    v_mov_b32 v182, 0
    v_mov_b32 v183, 0
    v_mov_b32 v184, 0
    v_mov_b32 v185, 0
    v_mov_b32 v186, 0
    v_mov_b32 v187, 0
    v_mov_b32 v188, 0
    v_mov_b32 v189, 0
    v_mov_b32 v190, 0
    v_mov_b32 v191, 0
    v_mov_b32 v192, 0
    v_mov_b32 v193, 0
    v_mov_b32 v194, 0
    v_mov_b32 v195, 0
    v_mov_b32 v196, 0
    v_mov_b32 v197, 0
    v_mov_b32 v198, 0
    v_mov_b32 v199, 0
    v_mov_b32 v200, 0
    v_mov_b32 v201, 0
    v_mov_b32 v202, 0
    v_mov_b32 v203, 0
    v_mov_b32 v204, 0
    v_mov_b32 v205, 0
    v_mov_b32 v206, 0
    v_mov_b32 v207, 0
    v_mov_b32 v208, 0
    v_mov_b32 v209, 0
    v_mov_b32 v210, 0
    v_mov_b32 v211, 0
    v_mov_b32 v212, 0
    v_mov_b32 v213, 0
    v_mov_b32 v214, 0
    v_mov_b32 v215, 0
    v_mov_b32 v216, 0
    v_mov_b32 v217, 0
    v_mov_b32 v218, 0
    v_mov_b32 v219, 0
    v_mov_b32 v220, 0
    v_mov_b32 v221, 0
    v_mov_b32 v222, 0
    v_mov_b32 v223, 0
    v_mov_b32 v224, 0
    v_mov_b32 v225, 0
    v_mov_b32 v226, 0
    v_mov_b32 v227, 0
    v_mov_b32 v228, 0
    v_mov_b32 v229, 0
    v_mov_b32 v230, 0
    v_mov_b32 v231, 0
    v_mov_b32 v232, 0
    v_mov_b32 v233, 0
    v_mov_b32 v234, 0
    v_mov_b32 v235, 0
    v_mov_b32 v236, 0
    v_mov_b32 v237, 0
    v_mov_b32 v238, 0
    v_mov_b32 v239, 0
    s_waitcnt vmcnt(2)
    s_barrier
    global_load_dwordx2 v[250:251], v7, s[18:19] sc1
    s_waitcnt vmcnt(0)
    s_barrier
    s_mov_b32 s53, 1000000
L_tagl_chk:
    v_readfirstlane_b32 s50, v250
    v_readfirstlane_b32 s51, v251
    s_nop 1
    s_cmp_lg_u64 s[50:51], 0
    s_cbranch_scc1 L_tagl_ok
    s_sub_u32 s53, s53, 1
    s_cbranch_scc1 L_tagl_ok
    global_load_dwordx2 v[250:251], v7, s[18:19] sc1
    s_waitcnt vmcnt(0)
    s_branch L_tagl_chk
L_tagl_ok:
    s_barrier
    s_branch L_attn
L_compute:
    s_mov_b32 s30, 1835008
    s_mov_b32 s31, 0x20000
    s_mov_b32 s34, 1204224
    s_mov_b32 s35, 0x20000
    s_waitcnt lgkmcnt(0)
    s_cmp_eq_u32 s24, 0
    s_cselect_b32 s28, s4, s10
    s_cselect_b32 s29, s5, s11
    s_cselect_b32 s32, s6, s12
    s_cselect_b32 s33, s7, s13
    s_cmp_lg_u32 s2, 0
    s_cbranch_scc1 L_notag
    s_cmp_lg_u32 s27, 0
    s_cbranch_scc1 L_notag
    s_memrealtime s[60:61]
    s_waitcnt lgkmcnt(0)
    s_or_b32 s60, s60, 1
    v_mov_b32 v18, s60
    v_mov_b32 v19, s61
    s_mov_b64 exec, 1
    global_store_dwordx2 v7, v[18:19], s[18:19] sc1
    s_mov_b64 exec, -1
L_notag:
    v_and_b32 v8, 31, v2
    v_lshrrev_b32 v9, 5, v2
    v_bfe_u32 v10, v2, 1, 3
    v_xor_b32 v10, v9, v10
    s_and_b32 s55, s48, 1
    s_lshl_b32 s55, s55, 13
    v_lshlrev_b32 v11, 7, v8
    v_add_u32 v11, s55, v11
    v_lshl_add_u32 v24, v10, 4, v11
    v_xor_b32 v12, 2, v10
    v_lshl_add_u32 v25, v12, 4, v11
    v_xor_b32 v12, 4, v10
    v_lshl_add_u32 v26, v12, 4, v11
    v_xor_b32 v12, 6, v10
    v_lshl_add_u32 v27, v12, 4, v11
    v_bfe_u32 v10, v2, 2, 2
    v_bfe_u32 v11, v2, 4, 1
    v_and_b32 v12, 3, v2
    v_lshl_add_u32 v11, v11, 2, v12
    s_lshr_b32 s55, s48, 1
    s_mul_i32 s55, s55, 7
    v_add_u32 v11, s55, v11
    v_lshrrev_b32 v12, 1, v11
    v_and_b32 v11, 1, v11
    v_lshlrev_b32 v11, 3, v11
    v_lshl_add_u32 v13, v9, 3, v10
    v_lshlrev_b32 v14, 2, v10
    v_xor_b32 v14, v12, v14
    v_lshl_add_u32 v14, v14, 4, v11
    v_lshl_add_u32 v14, v13, 8, v14
    v_add_u32 v28, 114688, v14
    v_xor_b32 v168, 128, v28
    v_lshrrev_b32 v14, 1, v10
    v_lshlrev_b32 v14, 2, v14
    v_xor_b32 v14, v12, v14
    v_lshl_add_u32 v14, v14, 4, v11
    v_lshl_add_u32 v14, v13, 7, v14
    v_add_u32 v169, 114688, v14
    v_and_b32 v29, 0x33, v2
    v_bfe_u32 v10, v2, 2, 1
    v_bfe_u32 v11, v2, 3, 1
    v_lshl_or_b32 v29, v10, 3, v29
    v_lshl_or_b32 v29, v11, 2, v29
    v_lshlrev_b32 v29, 4, v29
    v_cmp_gt_u32 s[56:57], 28, v8
    v_cmp_eq_u32 s[58:59], 28, v8
    v_mov_b32 v30, 0x3f803f80
    v_mov_b32 v31, 0x00003f80
    v_cndmask_b32 v1, 0, v30, s[58:59]
    s_lshl_b32 s60, s48, 13
    s_add_u32 s60, s60, 131072
    v_add_u32 v170, s60, v29
    v_add_u32 v171, s60, v3
    s_lshl_b32 s60, s48, 12
    s_add_u32 s60, s60, 65536
    v_add_u32 v172, s60, v3
    s_cmp_eq_u32 s24, 0
    s_mov_b32 s36, s20
    s_mov_b32 s37, s21
    s_mov_b32 s38, 13631488
    s_mov_b32 s39, 0x20000
    s_cselect_b32 s40, s8, s14
    s_cselect_b32 s41, s9, s15
    s_mov_b32 s42, 401408
    s_mov_b32 s43, 0x20000
    s_mov_b32 s44, s16
    s_mov_b32 s45, s17
    s_mov_b32 s46, 3670016
    s_mov_b32 s47, 0x20000
    v_mov_b32 v4, 0xdddddddd
    s_lshl_b32 s62, s24, 3
    s_add_u32 s62, s62, s26
    s_lshl_b32 s9, s62, 9
    s_add_u32 s9, s9, 12582912
    s_lshl_b32 s63, s48, 7
    s_add_u32 s10, s9, s63
    s_lshl_b32 s63, s25, 3
    s_add_u32 s10, s10, s63
    s_and_b32 s63, s48, 2
    s_add_u32 s63, s63, s49
    s_lshl_b32 s63, s63, 7
    s_add_u32 s9, s9, s63
    s_lshl_b32 s62, s62, 1
    s_lshr_b32 s101, s48, 1
    s_add_u32 s52, s62, s101
    s_and_b32 s100, s48, 1
    s_lshl_b32 s63, s49, 1
    s_add_u32 s100, s100, s63
    s_lshl_b32 s4, s52, 6
    s_add_u32 s4, s4, s100
    s_lshl_b32 s4, s4, 12
    s_lshl_b32 s62, s101, 14
    s_lshl_b32 s63, s100, 12
    s_add_u32 s63, s63, s62
    s_add_u32 s63, s63, 131072
    v_add_u32 v5, s63, v3
    s_mul_i32 s62, s101, 24576
    s_add_u32 s62, s62, 65536
    v_add_u32 v243, s62, v3
    s_lshl_b32 s8, s100, 12
    s_mul_i32 s7, s49, 49152
    s_and_b32 s63, s48, 1
    s_mul_i32 s63, s63, 12288
    s_add_u32 s7, s7, s63
    s_add_u32 s7, s7, 65536
    s_lshl_b32 s62, s101, 13
    s_add_u32 s62, s62, 65536
    v_add_u32 v6, s62, v3
    v_lshlrev_b32 v240, 3, v2
    v_mov_b32 v248, v240
    s_mul_i32 s62, s23, 37
    s_lshr_b32 s62, s62, 8
    s_mul_i32 s3, s62, 7
    s_sub_u32 s3, s23, s3
    s_lshl_b32 s12, s22, 2
    s_add_u32 s12, s12, s62
    s_lshl_b32 s12, s12, 2
    s_add_u32 s12, s12, s100
    v_lshrrev_b32 v241, 3, v2
    v_and_b32 v244, 7, v2
    v_bfe_u32 v245, v2, 4, 1
    v_lshlrev_b32 v245, 2, v245
    v_xor_b32 v244, v244, v245
    v_mul_u32_u24 v241, 896, v241
    v_lshl_add_u32 v241, v244, 4, v241
    s_mul_i32 s62, s27, 7168
    s_lshl_b32 s63, s3, 7
    s_add_u32 s62, s62, s63
    v_add_u32 v241, s62, v241
    s_lshl_b32 s13, s27, 10
    s_mov_b32 s11, 0
    s_lshl_b32 s62, s24, 4
    s_add_u32 s62, s62, s25
    s_lshl_b32 s62, s62, 2
    s_add_u32 s62, s62, s100
    s_lshl_b32 s62, s62, 4
    s_and_b32 s63, s52, 15
    s_add_u32 s62, s62, s63
    s_lshl_b32 s15, s62, 3
    s_add_u32 s15, s15, 12845056
    s_lshl_b32 s14, s62, 11
    s_add_u32 s14, s14, 8388608
    s_lshl_b32 s16, s12, 7
    s_lshl_b32 s62, s101, 6
    s_add_u32 s16, s16, s62
    s_add_u32 s16, s16, 12845056
    s_lshl_b32 s17, s12, 15
    s_lshl_b32 s62, s101, 14
    s_add_u32 s17, s17, s62
    s_add_u32 s17, s17, 8388608
    v_lshrrev_b32 v252, 5, v2
    v_bfe_u32 v253, v2, 2, 2
    v_lshl_add_u32 v244, v252, 2, v253
    v_lshlrev_b32 v244, 7, v244
    v_bfe_u32 v253, v2, 4, 1
    v_lshl_add_u32 v244, v253, 5, v244
    v_and_b32 v253, 3, v2
    v_lshl_add_u32 v244, v253, 3, v244
    v_bfe_u32 v253, v2, 3, 1
    v_lshl_add_u32 v244, v253, 6, v244
    s_mul_i32 s62, s101, 28672
    v_add_u32 v244, s62, v244
    v_and_b32 v253, 31, v2
    v_and_b32 v254, 7, v2
    v_xor_b32 v255, v252, v254
    v_lshlrev_b32 v255, 4, v255
    v_lshl_add_u32 v246, v253, 8, v255
    s_mul_i32 s62, s101, 24576
    s_add_u32 s62, s62, s7
    v_add_u32 v246, s62, v246
    v_lshrrev_b32 v253, 3, v2
    v_lshlrev_b32 v255, 1, v254
    v_xor_b32 v255, v255, v253
    v_lshlrev_b32 v255, 4, v255
    v_lshl_add_u32 v247, v253, 8, v255
    s_lshl_b32 s62, s101, 12
    s_add_u32 s62, s62, s7
    v_add_u32 v247, s62, v247
    s_and_b32 s62, s12, 63
    s_lshl_b32 s62, s62, 5
    s_lshl_b32 s63, s101, 4
    s_add_u32 s62, s62, s63
    v_add_u32 v253, s62, v253
    v_mul_u32_u24 v253, 1792, v253
    v_lshl_add_u32 v245, v254, 4, v253
    s_mul_i32 s62, s24, 896
    s_lshl_b32 s63, s3, 7
    s_add_u32 s62, s62, s63
    v_add_u32 v245, s62, v245
    s_mov_b32 s68, 0
    v_mov_b32 v176, 0
    v_mov_b32 v177, 0
    v_mov_b32 v178, 0
    v_mov_b32 v179, 0
    v_mov_b32 v180, 0
    v_mov_b32 v181, 0
    v_mov_b32 v182, 0
    v_mov_b32 v183, 0
    v_mov_b32 v184, 0
    v_mov_b32 v185, 0
    v_mov_b32 v186, 0
    v_mov_b32 v187, 0
    v_mov_b32 v188, 0
    v_mov_b32 v189, 0
    v_mov_b32 v190, 0
    v_mov_b32 v191, 0
    v_mov_b32 v192, 0
    v_mov_b32 v193, 0
    v_mov_b32 v194, 0
    v_mov_b32 v195, 0
    v_mov_b32 v196, 0
    v_mov_b32 v197, 0
    v_mov_b32 v198, 0
    v_mov_b32 v199, 0
    v_mov_b32 v200, 0
    v_mov_b32 v201, 0
    v_mov_b32 v202, 0
    v_mov_b32 v203, 0
    v_mov_b32 v204, 0
    v_mov_b32 v205, 0
    v_mov_b32 v206, 0
    v_mov_b32 v207, 0
    v_mov_b32 v208, 0
    v_mov_b32 v209, 0
    v_mov_b32 v210, 0
    v_mov_b32 v211, 0
    v_mov_b32 v212, 0
    v_mov_b32 v213, 0
    v_mov_b32 v214, 0
    v_mov_b32 v215, 0
    v_mov_b32 v216, 0
    v_mov_b32 v217, 0
    v_mov_b32 v218, 0
    v_mov_b32 v219, 0
    v_mov_b32 v220, 0
    v_mov_b32 v221, 0
    v_mov_b32 v222, 0
    v_mov_b32 v223, 0
    v_mov_b32 v224, 0
    v_mov_b32 v225, 0
    v_mov_b32 v226, 0
    v_mov_b32 v227, 0
    v_mov_b32 v228, 0
    v_mov_b32 v229, 0
    v_mov_b32 v230, 0
    v_mov_b32 v231, 0
    v_mov_b32 v232, 0
    v_mov_b32 v233, 0
    v_mov_b32 v234, 0
    v_mov_b32 v235, 0
    v_mov_b32 v236, 0
    v_mov_b32 v237, 0
    v_mov_b32 v238, 0
    v_mov_b32 v239, 0
    s_lshl_b32 s55, s52, 6
    s_lshl_b32 s60, s25, 2
    s_add_u32 s55, s55, s60
    s_and_b32 s60, s48, 1
    s_lshl_b32 s60, s60, 1
    s_add_u32 s55, s55, s60
    s_lshl_b32 s55, s55, 12
    s_mov_b32 s60, 0x3e8b97f6
    s_mov_b32 s61, s60
    v_cmp_gt_u32 vcc, 32, v2
    s_barrier
    ds_read_b128 v[128:131], v24 offset:0
    ds_read_b64_tr_b16 v[136:137], v28 offset:32768
    ds_read_b64_tr_b16 v[138:139], v28 offset:33792
    ds_read_b64_tr_b16 v[140:141], v168 offset:32768
    ds_read_b64_tr_b16 v[142:143], v168 offset:33792
    ds_read_b128 v[132:135], v24 offset:4096
    s_waitcnt lgkmcnt(0)
    v_mfma_f32_32x32x16_bf16 v[32:47], v[136:139], v[128:131], 0
    ds_read_b128 v[144:147], v25 offset:0
    ds_read_b64_tr_b16 v[152:153], v28 offset:36864
    ds_read_b64_tr_b16 v[154:155], v28 offset:37888
    v_mfma_f32_32x32x16_bf16 v[48:63], v[128:131], v[140:143], 0
    ds_read_b64_tr_b16 v[156:157], v168 offset:36864
    ds_read_b64_tr_b16 v[158:159], v168 offset:37888
    ds_read_b128 v[148:151], v25 offset:4096
    v_mfma_f32_32x32x16_bf16 v[64:79], v[136:139], v[132:135], 0
    v_mfma_f32_32x32x16_bf16 v[80:95], v[132:135], v[140:143], 0
    s_waitcnt lgkmcnt(0)
    v_mfma_f32_32x32x16_bf16 v[32:47], v[152:155], v[144:147], v[32:47]
    ds_read_b128 v[128:131], v26 offset:0
    ds_read_b64_tr_b16 v[136:137], v28 offset:40960
    ds_read_b64_tr_b16 v[138:139], v28 offset:41984
    v_mfma_f32_32x32x16_bf16 v[48:63], v[144:147], v[156:159], v[48:63]
    ds_read_b64_tr_b16 v[140:141], v168 offset:40960
    ds_read_b64_tr_b16 v[142:143], v168 offset:41984
    ds_read_b128 v[132:135], v26 offset:4096
    v_mfma_f32_32x32x16_bf16 v[64:79], v[152:155], v[148:151], v[64:79]
    v_mfma_f32_32x32x16_bf16 v[80:95], v[148:151], v[156:159], v[80:95]
    s_waitcnt lgkmcnt(0)
    v_mfma_f32_32x32x16_bf16 v[32:47], v[136:139], v[128:131], v[32:47]
    ds_read_b128 v[144:147], v27 offset:0
    ds_read_b64_tr_b16 v[152:153], v28 offset:45056
    ds_read_b64_tr_b16 v[154:155], v28 offset:46080
    v_mfma_f32_32x32x16_bf16 v[48:63], v[128:131], v[140:143], v[48:63]
    ds_read_b64_tr_b16 v[156:157], v168 offset:45056
    ds_read_b64_tr_b16 v[158:159], v168 offset:46080
    ds_read_b128 v[148:151], v27 offset:4096
    v_mfma_f32_32x32x16_bf16 v[64:79], v[136:139], v[132:135], v[64:79]
    v_mfma_f32_32x32x16_bf16 v[80:95], v[132:135], v[140:143], v[80:95]
    s_waitcnt lgkmcnt(0)
    v_mfma_f32_32x32x16_bf16 v[32:47], v[152:155], v[144:147], v[32:47]
    s_barrier
    ds_read_b128 v[128:131], v24 offset:16384
    ds_read_b64_tr_b16 v[136:137], v28 offset:0
    ds_read_b64_tr_b16 v[138:139], v28 offset:1024
    v_mfma_f32_32x32x16_bf16 v[48:63], v[144:147], v[156:159], v[48:63]
    ds_read_b64_tr_b16 v[140:141], v168 offset:0
    ds_read_b64_tr_b16 v[142:143], v168 offset:1024
    ds_read_b128 v[132:135], v24 offset:20480
    v_mfma_f32_32x32x16_bf16 v[64:79], v[152:155], v[148:151], v[64:79]
    v_mfma_f32_32x32x16_bf16 v[80:95], v[148:151], v[156:159], v[80:95]
    s_waitcnt lgkmcnt(0)
    v_mfma_f32_32x32x16_bf16 v[32:47], v[136:139], v[128:131], v[32:47]
    ds_read_b128 v[144:147], v25 offset:16384
    ds_read_b64_tr_b16 v[152:153], v28 offset:4096
    ds_read_b64_tr_b16 v[154:155], v28 offset:5120
    v_mfma_f32_32x32x16_bf16 v[48:63], v[128:131], v[140:143], v[48:63]
    ds_read_b64_tr_b16 v[156:157], v168 offset:4096
    ds_read_b64_tr_b16 v[158:159], v168 offset:5120
    ds_read_b128 v[148:151], v25 offset:20480
    v_mfma_f32_32x32x16_bf16 v[64:79], v[136:139], v[132:135], v[64:79]
    v_mfma_f32_32x32x16_bf16 v[80:95], v[132:135], v[140:143], v[80:95]
    s_waitcnt lgkmcnt(0)
    v_mfma_f32_32x32x16_bf16 v[32:47], v[152:155], v[144:147], v[32:47]
    ds_read_b128 v[128:131], v26 offset:16384
    ds_read_b64_tr_b16 v[136:137], v28 offset:8192
    ds_read_b64_tr_b16 v[138:139], v28 offset:9216
    v_mfma_f32_32x32x16_bf16 v[48:63], v[144:147], v[156:159], v[48:63]
    ds_read_b64_tr_b16 v[140:141], v168 offset:8192
    ds_read_b64_tr_b16 v[142:143], v168 offset:9216
    ds_read_b128 v[132:135], v26 offset:20480
    v_mfma_f32_32x32x16_bf16 v[64:79], v[152:155], v[148:151], v[64:79]
    v_mfma_f32_32x32x16_bf16 v[80:95], v[148:151], v[156:159], v[80:95]
    s_waitcnt lgkmcnt(0)
    v_mfma_f32_32x32x16_bf16 v[32:47], v[136:139], v[128:131], v[32:47]
    ds_read_b128 v[144:147], v27 offset:16384
    ds_read_b64_tr_b16 v[152:153], v28 offset:12288
    ds_read_b64_tr_b16 v[154:155], v28 offset:13312
    v_mfma_f32_32x32x16_bf16 v[48:63], v[128:131], v[140:143], v[48:63]
    ds_read_b64_tr_b16 v[156:157], v168 offset:12288
    ds_read_b64_tr_b16 v[158:159], v168 offset:13312
    ds_read_b128 v[148:151], v27 offset:20480
    v_mfma_f32_32x32x16_bf16 v[64:79], v[136:139], v[132:135], v[64:79]
    v_mfma_f32_32x32x16_bf16 v[80:95], v[132:135], v[140:143], v[80:95]
    s_waitcnt lgkmcnt(0)
    v_mfma_f32_32x32x16_bf16 v[32:47], v[152:155], v[144:147], v[32:47]
    s_barrier
    ds_read_b128 v[128:131], v24 offset:32768
    ds_read_b64_tr_b16 v[136:137], v28 offset:16384
    ds_read_b64_tr_b16 v[138:139], v28 offset:17408
    v_mfma_f32_32x32x16_bf16 v[48:63], v[144:147], v[156:159], v[48:63]
    ds_read_b64_tr_b16 v[140:141], v168 offset:16384
    ds_read_b64_tr_b16 v[142:143], v168 offset:17408
    ds_read_b128 v[132:135], v24 offset:36864
    v_mfma_f32_32x32x16_bf16 v[64:79], v[152:155], v[148:151], v[64:79]
    v_mfma_f32_32x32x16_bf16 v[80:95], v[148:151], v[156:159], v[80:95]
    s_waitcnt lgkmcnt(0)
    v_mfma_f32_32x32x16_bf16 v[32:47], v[136:139], v[128:131], v[32:47]
    ds_read_b128 v[144:147], v25 offset:32768
    ds_read_b64_tr_b16 v[152:153], v28 offset:20480
    ds_read_b64_tr_b16 v[154:155], v28 offset:21504
    v_mfma_f32_32x32x16_bf16 v[48:63], v[128:131], v[140:143], v[48:63]
    ds_read_b64_tr_b16 v[156:157], v168 offset:20480
    ds_read_b64_tr_b16 v[158:159], v168 offset:21504
    ds_read_b128 v[148:151], v25 offset:36864
    v_mfma_f32_32x32x16_bf16 v[64:79], v[136:139], v[132:135], v[64:79]
    v_mfma_f32_32x32x16_bf16 v[80:95], v[132:135], v[140:143], v[80:95]
    s_waitcnt lgkmcnt(0)
    v_mfma_f32_32x32x16_bf16 v[32:47], v[152:155], v[144:147], v[32:47]
    ds_read_b128 v[128:131], v26 offset:32768
    ds_read_b64_tr_b16 v[136:137], v28 offset:24576
    ds_read_b64_tr_b16 v[138:139], v28 offset:25600
    v_mfma_f32_32x32x16_bf16 v[48:63], v[144:147], v[156:159], v[48:63]
    ds_read_b64_tr_b16 v[140:141], v168 offset:24576
    ds_read_b64_tr_b16 v[142:143], v168 offset:25600
    ds_read_b128 v[132:135], v26 offset:36864
    v_mfma_f32_32x32x16_bf16 v[64:79], v[152:155], v[148:151], v[64:79]
    v_mfma_f32_32x32x16_bf16 v[80:95], v[148:151], v[156:159], v[80:95]
    s_waitcnt lgkmcnt(0)
    v_mfma_f32_32x32x16_bf16 v[32:47], v[136:139], v[128:131], v[32:47]
    ds_read_b128 v[144:147], v27 offset:32768
    ds_read_b64_tr_b16 v[152:153], v28 offset:28672
    ds_read_b64_tr_b16 v[154:155], v28 offset:29696
    v_mfma_f32_32x32x16_bf16 v[48:63], v[128:131], v[140:143], v[48:63]
    ds_read_b64_tr_b16 v[156:157], v168 offset:28672
    ds_read_b64_tr_b16 v[158:159], v168 offset:29696
    ds_read_b128 v[148:151], v27 offset:36864
    v_mfma_f32_32x32x16_bf16 v[64:79], v[136:139], v[132:135], v[64:79]
    v_mfma_f32_32x32x16_bf16 v[80:95], v[132:135], v[140:143], v[80:95]
    s_waitcnt lgkmcnt(0)
    v_mfma_f32_32x32x16_bf16 v[32:47], v[152:155], v[144:147], v[32:47]
    s_barrier
    ds_read_b128 v[128:131], v24 offset:49152
    ds_read_b64_tr_b16 v[136:137], v28 offset:32768
    ds_read_b64_tr_b16 v[138:139], v28 offset:33792
    v_mfma_f32_32x32x16_bf16 v[48:63], v[144:147], v[156:159], v[48:63]
    ds_read_b64_tr_b16 v[140:141], v168 offset:32768
    ds_read_b64_tr_b16 v[142:143], v168 offset:33792
    ds_read_b128 v[132:135], v24 offset:53248
    v_mfma_f32_32x32x16_bf16 v[64:79], v[152:155], v[148:151], v[64:79]
    v_mfma_f32_32x32x16_bf16 v[80:95], v[148:151], v[156:159], v[80:95]
    s_waitcnt lgkmcnt(0)
    v_mfma_f32_32x32x16_bf16 v[32:47], v[136:139], v[128:131], v[32:47]
    ds_read_b128 v[144:147], v25 offset:49152
    ds_read_b64_tr_b16 v[152:153], v28 offset:36864
    ds_read_b64_tr_b16 v[154:155], v28 offset:37888
    v_mfma_f32_32x32x16_bf16 v[48:63], v[128:131], v[140:143], v[48:63]
    ds_read_b64_tr_b16 v[156:157], v168 offset:36864
    ds_read_b64_tr_b16 v[158:159], v168 offset:37888
    ds_read_b128 v[148:151], v25 offset:53248
    v_mfma_f32_32x32x16_bf16 v[64:79], v[136:139], v[132:135], v[64:79]
    v_mfma_f32_32x32x16_bf16 v[80:95], v[132:135], v[140:143], v[80:95]
    s_waitcnt lgkmcnt(0)
    v_mfma_f32_32x32x16_bf16 v[32:47], v[152:155], v[144:147], v[32:47]
    ds_read_b128 v[128:131], v26 offset:49152
    ds_read_b64_tr_b16 v[136:137], v28 offset:40960
    ds_read_b64_tr_b16 v[138:139], v28 offset:41984
    v_mfma_f32_32x32x16_bf16 v[48:63], v[144:147], v[156:159], v[48:63]
    ds_read_b64_tr_b16 v[140:141], v168 offset:40960
    ds_read_b64_tr_b16 v[142:143], v168 offset:41984
    ds_read_b128 v[132:135], v26 offset:53248
    v_mfma_f32_32x32x16_bf16 v[64:79], v[152:155], v[148:151], v[64:79]
    v_mfma_f32_32x32x16_bf16 v[80:95], v[148:151], v[156:159], v[80:95]
    s_waitcnt lgkmcnt(0)
    v_mfma_f32_32x32x16_bf16 v[32:47], v[136:139], v[128:131], v[32:47]
    ds_read_b128 v[144:147], v27 offset:49152
    ds_read_b64_tr_b16 v[152:153], v28 offset:45056
    ds_read_b64_tr_b16 v[154:155], v28 offset:46080
    v_mfma_f32_32x32x16_bf16 v[48:63], v[128:131], v[140:143], v[48:63]
    ds_read_b64_tr_b16 v[156:157], v168 offset:45056
    ds_read_b64_tr_b16 v[158:159], v168 offset:46080
    ds_read_b128 v[148:151], v27 offset:53248
    v_mfma_f32_32x32x16_bf16 v[64:79], v[136:139], v[132:135], v[64:79]
    v_mfma_f32_32x32x16_bf16 v[80:95], v[132:135], v[140:143], v[80:95]
    s_waitcnt lgkmcnt(0)
    v_mfma_f32_32x32x16_bf16 v[32:47], v[152:155], v[144:147], v[32:47]
    v_add_u32 v24, 65536, v24
    v_add_u32 v25, 65536, v25
    v_add_u32 v26, 65536, v26
    v_add_u32 v27, 65536, v27
    s_barrier
    ds_read_b128 v[128:131], v24 offset:0
    ds_read_b64_tr_b16 v[136:137], v28 offset:0
    ds_read_b64_tr_b16 v[138:139], v28 offset:1024
    v_mfma_f32_32x32x16_bf16 v[48:63], v[144:147], v[156:159], v[48:63]
    ds_read_b64_tr_b16 v[140:141], v168 offset:0
    ds_read_b64_tr_b16 v[142:143], v168 offset:1024
    ds_read_b128 v[132:135], v24 offset:4096
    v_mfma_f32_32x32x16_bf16 v[64:79], v[152:155], v[148:151], v[64:79]
    v_mfma_f32_32x32x16_bf16 v[80:95], v[148:151], v[156:159], v[80:95]
    s_waitcnt lgkmcnt(0)
    v_mfma_f32_32x32x16_bf16 v[32:47], v[136:139], v[128:131], v[32:47]
    ds_read_b128 v[144:147], v25 offset:0
    ds_read_b64_tr_b16 v[152:153], v28 offset:4096
    ds_read_b64_tr_b16 v[154:155], v28 offset:5120
    v_mfma_f32_32x32x16_bf16 v[48:63], v[128:131], v[140:143], v[48:63]
    ds_read_b64_tr_b16 v[156:157], v168 offset:4096
    ds_read_b64_tr_b16 v[158:159], v168 offset:5120
    ds_read_b128 v[148:151], v25 offset:4096
    v_mfma_f32_32x32x16_bf16 v[64:79], v[136:139], v[132:135], v[64:79]
    v_mfma_f32_32x32x16_bf16 v[80:95], v[132:135], v[140:143], v[80:95]
    s_waitcnt lgkmcnt(0)
    v_mfma_f32_32x32x16_bf16 v[32:47], v[152:155], v[144:147], v[32:47]
    ds_read_b128 v[128:131], v26 offset:0
    ds_read_b64_tr_b16 v[136:137], v28 offset:8192
    ds_read_b64_tr_b16 v[138:139], v28 offset:9216
    v_mfma_f32_32x32x16_bf16 v[48:63], v[144:147], v[156:159], v[48:63]
    ds_read_b64_tr_b16 v[140:141], v168 offset:8192
    ds_read_b64_tr_b16 v[142:143], v168 offset:9216
    ds_read_b128 v[132:135], v26 offset:4096
    v_mfma_f32_32x32x16_bf16 v[64:79], v[152:155], v[148:151], v[64:79]
    v_mfma_f32_32x32x16_bf16 v[80:95], v[148:151], v[156:159], v[80:95]
    global_load_dwordx2 v[174:175], v7, s[18:19] sc1
    s_waitcnt lgkmcnt(0)
    v_mfma_f32_32x32x16_bf16 v[32:47], v[136:139], v[128:131], v[32:47]
    ds_read_b128 v[144:147], v27 offset:0
    ds_read_b64_tr_b16 v[152:153], v28 offset:12288
    ds_read_b64_tr_b16 v[154:155], v28 offset:13312
    v_mfma_f32_32x32x16_bf16 v[48:63], v[128:131], v[140:143], v[48:63]
    ds_read_b64_tr_b16 v[156:157], v168 offset:12288
    ds_read_b64_tr_b16 v[158:159], v168 offset:13312
    ds_read_b128 v[148:151], v27 offset:4096
    v_mfma_f32_32x32x16_bf16 v[64:79], v[136:139], v[132:135], v[64:79]
    v_mfma_f32_32x32x16_bf16 v[80:95], v[132:135], v[140:143], v[80:95]
    s_waitcnt lgkmcnt(0)
    v_mfma_f32_32x32x16_bf16 v[32:47], v[152:155], v[144:147], v[32:47]
    s_barrier
    ds_read_b128 v[128:131], v24 offset:16384
    ds_read_b64_tr_b16 v[136:137], v28 offset:16384
    ds_read_b64_tr_b16 v[138:139], v28 offset:17408
    v_mfma_f32_32x32x16_bf16 v[48:63], v[144:147], v[156:159], v[48:63]
    ds_read_b64_tr_b16 v[140:141], v168 offset:16384
    ds_read_b64_tr_b16 v[142:143], v168 offset:17408
    ds_read_b128 v[132:135], v24 offset:20480
    v_mfma_f32_32x32x16_bf16 v[64:79], v[152:155], v[148:151], v[64:79]
    v_mfma_f32_32x32x16_bf16 v[80:95], v[148:151], v[156:159], v[80:95]
    s_waitcnt lgkmcnt(0)
    v_mfma_f32_32x32x16_bf16 v[32:47], v[136:139], v[128:131], v[32:47]
    ds_read_b128 v[144:147], v25 offset:16384
    ds_read_b64_tr_b16 v[152:153], v28 offset:20480
    ds_read_b64_tr_b16 v[154:155], v28 offset:21504
    v_mfma_f32_32x32x16_bf16 v[48:63], v[128:131], v[140:143], v[48:63]
    ds_read_b64_tr_b16 v[156:157], v168 offset:20480
    ds_read_b64_tr_b16 v[158:159], v168 offset:21504
    ds_read_b128 v[148:151], v25 offset:20480
    v_mfma_f32_32x32x16_bf16 v[64:79], v[136:139], v[132:135], v[64:79]
    v_mfma_f32_32x32x16_bf16 v[80:95], v[132:135], v[140:143], v[80:95]
    s_waitcnt lgkmcnt(0)
    v_mfma_f32_32x32x16_bf16 v[32:47], v[152:155], v[144:147], v[32:47]
    ds_read_b128 v[128:131], v26 offset:16384
    ds_read_b64_tr_b16 v[136:137], v28 offset:24576
    ds_read_b64_tr_b16 v[138:139], v28 offset:25600
    v_mfma_f32_32x32x16_bf16 v[48:63], v[144:147], v[156:159], v[48:63]
    ds_read_b64_tr_b16 v[140:141], v168 offset:24576
    ds_read_b64_tr_b16 v[142:143], v168 offset:25600
    ds_read_b128 v[132:135], v26 offset:20480
    v_mfma_f32_32x32x16_bf16 v[64:79], v[152:155], v[148:151], v[64:79]
    v_mfma_f32_32x32x16_bf16 v[80:95], v[148:151], v[156:159], v[80:95]
    s_waitcnt lgkmcnt(0)
    v_mfma_f32_32x32x16_bf16 v[32:47], v[136:139], v[128:131], v[32:47]
    ds_read_b128 v[144:147], v27 offset:16384
    ds_read_b64_tr_b16 v[152:153], v28 offset:28672
    ds_read_b64_tr_b16 v[154:155], v28 offset:29696
    v_mfma_f32_32x32x16_bf16 v[48:63], v[128:131], v[140:143], v[48:63]
    ds_read_b64_tr_b16 v[156:157], v168 offset:28672
    ds_read_b64_tr_b16 v[158:159], v168 offset:29696
    ds_read_b128 v[148:151], v27 offset:20480
    v_mfma_f32_32x32x16_bf16 v[64:79], v[136:139], v[132:135], v[64:79]
    v_mfma_f32_32x32x16_bf16 v[80:95], v[132:135], v[140:143], v[80:95]
    s_waitcnt lgkmcnt(0)
    v_mfma_f32_32x32x16_bf16 v[32:47], v[152:155], v[144:147], v[32:47]
    s_barrier
    ds_read_b128 v[128:131], v24 offset:32768
    ds_read_b64_tr_b16 v[136:137], v28 offset:32768
    ds_read_b64_tr_b16 v[138:139], v28 offset:33792
    v_mfma_f32_32x32x16_bf16 v[48:63], v[144:147], v[156:159], v[48:63]
    ds_read_b64_tr_b16 v[140:141], v168 offset:32768
    ds_read_b64_tr_b16 v[142:143], v168 offset:33792
    ds_read_b128 v[132:135], v24 offset:36864
    v_mfma_f32_32x32x16_bf16 v[64:79], v[152:155], v[148:151], v[64:79]
    v_mfma_f32_32x32x16_bf16 v[80:95], v[148:151], v[156:159], v[80:95]
    s_waitcnt lgkmcnt(0)
    v_mfma_f32_32x32x16_bf16 v[32:47], v[136:139], v[128:131], v[32:47]
    ds_read_b128 v[144:147], v25 offset:32768
    ds_read_b64_tr_b16 v[152:153], v28 offset:36864
    ds_read_b64_tr_b16 v[154:155], v28 offset:37888
    v_mfma_f32_32x32x16_bf16 v[48:63], v[128:131], v[140:143], v[48:63]
    ds_read_b64_tr_b16 v[156:157], v168 offset:36864
    ds_read_b64_tr_b16 v[158:159], v168 offset:37888
    ds_read_b128 v[148:151], v25 offset:36864
    v_mfma_f32_32x32x16_bf16 v[64:79], v[136:139], v[132:135], v[64:79]
    v_mfma_f32_32x32x16_bf16 v[80:95], v[132:135], v[140:143], v[80:95]
    s_waitcnt lgkmcnt(0)
    v_mfma_f32_32x32x16_bf16 v[32:47], v[152:155], v[144:147], v[32:47]
    ds_read_b128 v[128:131], v26 offset:32768
    ds_read_b64_tr_b16 v[136:137], v28 offset:40960
    ds_read_b64_tr_b16 v[138:139], v28 offset:41984
    v_mfma_f32_32x32x16_bf16 v[48:63], v[144:147], v[156:159], v[48:63]
    ds_read_b64_tr_b16 v[140:141], v168 offset:40960
    ds_read_b64_tr_b16 v[142:143], v168 offset:41984
    ds_read_b128 v[132:135], v26 offset:36864
    v_mfma_f32_32x32x16_bf16 v[64:79], v[152:155], v[148:151], v[64:79]
    v_mfma_f32_32x32x16_bf16 v[80:95], v[148:151], v[156:159], v[80:95]
    s_waitcnt lgkmcnt(0)
    v_mfma_f32_32x32x16_bf16 v[32:47], v[136:139], v[128:131], v[32:47]
    ds_read_b128 v[144:147], v27 offset:32768
    ds_read_b64_tr_b16 v[152:153], v28 offset:45056
    ds_read_b64_tr_b16 v[154:155], v28 offset:46080
    v_mfma_f32_32x32x16_bf16 v[48:63], v[128:131], v[140:143], v[48:63]
    ds_read_b64_tr_b16 v[156:157], v168 offset:45056
    ds_read_b64_tr_b16 v[158:159], v168 offset:46080
    ds_read_b128 v[148:151], v27 offset:36864
    v_mfma_f32_32x32x16_bf16 v[64:79], v[136:139], v[132:135], v[64:79]
    v_mfma_f32_32x32x16_bf16 v[80:95], v[132:135], v[140:143], v[80:95]
    s_waitcnt lgkmcnt(0)
    v_mfma_f32_32x32x16_bf16 v[32:47], v[152:155], v[144:147], v[32:47]
    v_add_u32 v24, 4294901760, v24
    v_add_u32 v25, 4294901760, v25
    v_add_u32 v26, 4294901760, v26
    v_add_u32 v27, 4294901760, v27
    s_barrier
    ds_read_b128 v[128:131], v24 offset:0
    ds_read_b64_tr_b16 v[136:137], v169 offset:0
    ds_read_b64_tr_b16 v[138:139], v169 offset:512
    v_mfma_f32_32x32x16_bf16 v[48:63], v[144:147], v[156:159], v[48:63]
    ds_read_b128 v[132:135], v24 offset:4096
    v_mfma_f32_32x32x16_bf16 v[64:79], v[152:155], v[148:151], v[64:79]
    v_mfma_f32_32x32x16_bf16 v[80:95], v[148:151], v[156:159], v[80:95]
    ds_read_b128 v[140:143], v25 offset:0
    ds_read_b64_tr_b16 v[148:149], v169 offset:2048
    ds_read_b64_tr_b16 v[150:151], v169 offset:2560
    ds_read_b128 v[144:147], v25 offset:4096
    s_waitcnt lgkmcnt(4)
    v_mfma_f32_32x32x16_bf16 v[96:111], v[136:139], v[128:131], 0
    ds_read_b128 v[152:155], v26 offset:0
    ds_read_b64_tr_b16 v[160:161], v169 offset:4096
    ds_read_b64_tr_b16 v[162:163], v169 offset:4608
    ds_read_b128 v[156:159], v26 offset:4096
    v_cvt_pk_bf16_f32 v32, v32, v33
    v_cvt_pk_bf16_f32 v33, v34, v35
    v_cvt_pk_bf16_f32 v34, v36, v37
    v_cvt_pk_bf16_f32 v35, v38, v39
    v_cvt_pk_bf16_f32 v36, v40, v41
    v_cvt_pk_bf16_f32 v37, v42, v43
    v_cvt_pk_bf16_f32 v38, v44, v45
    v_cvt_pk_bf16_f32 v39, v46, v47
    v_mfma_f32_32x32x16_bf16 v[112:127], v[136:139], v[132:135], 0
    v_cndmask_b32 v38, v30, v38, vcc
    v_cndmask_b32 v39, v31, v39, vcc
    buffer_store_dwordx4 v[32:35], v29, s[36:39], s55 offen sc1
    buffer_store_dwordx4 v[36:39], v29, s[36:39], s55 offen offset:1024 sc1
    v_cvt_pk_bf16_f32 v48, v48, v49
    v_cvt_pk_bf16_f32 v49, v50, v51
    v_cvt_pk_bf16_f32 v50, v52, v53
    v_cvt_pk_bf16_f32 v51, v54, v55
    s_waitcnt lgkmcnt(4)
    v_mfma_f32_32x32x16_bf16 v[96:111], v[148:151], v[140:143], v[96:111]
    ds_read_b128 v[128:131], v27 offset:0
    ds_read_b64_tr_b16 v[136:137], v169 offset:6144
    ds_read_b64_tr_b16 v[138:139], v169 offset:6656
    ds_read_b128 v[132:135], v27 offset:4096
    v_cvt_pk_bf16_f32 v52, v56, v57
    v_cvt_pk_bf16_f32 v53, v58, v59
    v_cvt_pk_bf16_f32 v54, v60, v61
    v_cvt_pk_bf16_f32 v55, v62, v63
    v_cndmask_b32 v48, v1, v48, s[56:57]
    v_cndmask_b32 v49, v1, v49, s[56:57]
    v_cndmask_b32 v50, v1, v50, s[56:57]
    v_cndmask_b32 v51, v1, v51, s[56:57]
    v_mfma_f32_32x32x16_bf16 v[112:127], v[148:151], v[144:147], v[112:127]
    v_cndmask_b32 v52, v1, v52, s[56:57]
    v_cndmask_b32 v53, v1, v53, s[56:57]
    v_cndmask_b32 v54, v1, v54, s[56:57]
    v_cndmask_b32 v55, v1, v55, s[56:57]
    buffer_store_dwordx4 v[48:51], v3, s[36:39], s55 offen offset:2048 sc1
    buffer_store_dwordx4 v[52:55], v3, s[36:39], s55 offen offset:3072 sc1
    s_add_u32 s55, s55, 4096
    v_cvt_pk_bf16_f32 v64, v64, v65
    s_waitcnt lgkmcnt(4)
    v_mfma_f32_32x32x16_bf16 v[96:111], v[160:163], v[152:155], v[96:111]
    ds_read_b128 v[140:143], v24 offset:16384
    ds_read_b64_tr_b16 v[148:149], v169 offset:8192
    ds_read_b64_tr_b16 v[150:151], v169 offset:8704
    ds_read_b128 v[144:147], v24 offset:20480
    v_cvt_pk_bf16_f32 v65, v66, v67
    v_cvt_pk_bf16_f32 v66, v68, v69
    v_cvt_pk_bf16_f32 v67, v70, v71
    v_cvt_pk_bf16_f32 v68, v72, v73
    v_cvt_pk_bf16_f32 v69, v74, v75
    v_cvt_pk_bf16_f32 v70, v76, v77
    v_cvt_pk_bf16_f32 v71, v78, v79
    v_cndmask_b32 v70, v30, v70, vcc
    v_mfma_f32_32x32x16_bf16 v[112:127], v[160:163], v[156:159], v[112:127]
    v_cndmask_b32 v71, v31, v71, vcc
    buffer_store_dwordx4 v[64:67], v29, s[36:39], s55 offen sc1
    buffer_store_dwordx4 v[68:71], v29, s[36:39], s55 offen offset:1024 sc1
    v_cvt_pk_bf16_f32 v80, v80, v81
    v_cvt_pk_bf16_f32 v81, v82, v83
    v_cvt_pk_bf16_f32 v82, v84, v85
    v_cvt_pk_bf16_f32 v83, v86, v87
    v_cvt_pk_bf16_f32 v84, v88, v89
    s_waitcnt lgkmcnt(4)
    v_mfma_f32_32x32x16_bf16 v[96:111], v[136:139], v[128:131], v[96:111]
    ds_read_b128 v[152:155], v25 offset:16384
    ds_read_b64_tr_b16 v[160:161], v169 offset:10240
    ds_read_b64_tr_b16 v[162:163], v169 offset:10752
    ds_read_b128 v[156:159], v25 offset:20480
    v_cvt_pk_bf16_f32 v85, v90, v91
    v_cvt_pk_bf16_f32 v86, v92, v93
    v_cvt_pk_bf16_f32 v87, v94, v95
    v_cndmask_b32 v80, v1, v80, s[56:57]
    v_cndmask_b32 v81, v1, v81, s[56:57]
    v_cndmask_b32 v82, v1, v82, s[56:57]
    v_cndmask_b32 v83, v1, v83, s[56:57]
    v_cndmask_b32 v84, v1, v84, s[56:57]
    v_mfma_f32_32x32x16_bf16 v[112:127], v[136:139], v[132:135], v[112:127]
    v_cndmask_b32 v85, v1, v85, s[56:57]
    v_cndmask_b32 v86, v1, v86, s[56:57]
    v_cndmask_b32 v87, v1, v87, s[56:57]
    buffer_store_dwordx4 v[80:83], v3, s[36:39], s55 offen offset:2048 sc1
    buffer_store_dwordx4 v[84:87], v3, s[36:39], s55 offen offset:3072 sc1
    s_waitcnt lgkmcnt(4)
    v_mfma_f32_32x32x16_bf16 v[96:111], v[148:151], v[140:143], v[96:111]
    ds_read_b128 v[128:131], v26 offset:16384
    ds_read_b64_tr_b16 v[136:137], v169 offset:12288
    ds_read_b64_tr_b16 v[138:139], v169 offset:12800
    ds_read_b128 v[132:135], v26 offset:20480
    v_mfma_f32_32x32x16_bf16 v[112:127], v[148:151], v[144:147], v[112:127]
    s_waitcnt lgkmcnt(4)
    v_mfma_f32_32x32x16_bf16 v[96:111], v[160:163], v[152:155], v[96:111]
    ds_read_b128 v[140:143], v27 offset:16384
    ds_read_b64_tr_b16 v[148:149], v169 offset:14336
    ds_read_b64_tr_b16 v[150:151], v169 offset:14848
    ds_read_b128 v[144:147], v27 offset:20480
    v_mfma_f32_32x32x16_bf16 v[112:127], v[160:163], v[156:159], v[112:127]
    s_waitcnt lgkmcnt(0)
    v_mfma_f32_32x32x16_bf16 v[96:111], v[136:139], v[128:131], v[96:111]
    s_barrier
    ds_read_b128 v[152:155], v24 offset:32768
    ds_read_b64_tr_b16 v[160:161], v169 offset:16384
    ds_read_b64_tr_b16 v[162:163], v169 offset:16896
    ds_read_b128 v[156:159], v24 offset:36864
    v_mfma_f32_32x32x16_bf16 v[112:127], v[136:139], v[132:135], v[112:127]
    s_waitcnt lgkmcnt(4)
    v_mfma_f32_32x32x16_bf16 v[96:111], v[148:151], v[140:143], v[96:111]
    ds_read_b128 v[128:131], v25 offset:32768
    ds_read_b64_tr_b16 v[136:137], v169 offset:18432
    ds_read_b64_tr_b16 v[138:139], v169 offset:18944
    ds_read_b128 v[132:135], v25 offset:36864
    v_mfma_f32_32x32x16_bf16 v[112:127], v[148:151], v[144:147], v[112:127]
    s_waitcnt lgkmcnt(4)
    v_mfma_f32_32x32x16_bf16 v[96:111], v[160:163], v[152:155], v[96:111]
    ds_read_b128 v[140:143], v26 offset:32768
    ds_read_b64_tr_b16 v[148:149], v169 offset:20480
    ds_read_b64_tr_b16 v[150:151], v169 offset:20992
    ds_read_b128 v[144:147], v26 offset:36864
    v_mfma_f32_32x32x16_bf16 v[112:127], v[160:163], v[156:159], v[112:127]
    s_waitcnt lgkmcnt(4)
    v_mfma_f32_32x32x16_bf16 v[96:111], v[136:139], v[128:131], v[96:111]
    ds_read_b128 v[152:155], v27 offset:32768
    ds_read_b64_tr_b16 v[160:161], v169 offset:22528
    ds_read_b64_tr_b16 v[162:163], v169 offset:23040
    ds_read_b128 v[156:159], v27 offset:36864
    v_mfma_f32_32x32x16_bf16 v[112:127], v[136:139], v[132:135], v[112:127]
    s_waitcnt lgkmcnt(4)
    v_mfma_f32_32x32x16_bf16 v[96:111], v[148:151], v[140:143], v[96:111]
    ds_read_b128 v[128:131], v24 offset:49152
    ds_read_b64_tr_b16 v[136:137], v169 offset:24576
    ds_read_b64_tr_b16 v[138:139], v169 offset:25088
    ds_read_b128 v[132:135], v24 offset:53248
    v_mfma_f32_32x32x16_bf16 v[112:127], v[148:151], v[144:147], v[112:127]
    s_waitcnt lgkmcnt(4)
    v_mfma_f32_32x32x16_bf16 v[96:111], v[160:163], v[152:155], v[96:111]
    ds_read_b128 v[140:143], v25 offset:49152
    ds_read_b64_tr_b16 v[148:149], v169 offset:26624
    ds_read_b64_tr_b16 v[150:151], v169 offset:27136
    ds_read_b128 v[144:147], v25 offset:53248
    v_mfma_f32_32x32x16_bf16 v[112:127], v[160:163], v[156:159], v[112:127]
    s_waitcnt lgkmcnt(4)
    v_mfma_f32_32x32x16_bf16 v[96:111], v[136:139], v[128:131], v[96:111]
    ds_read_b128 v[152:155], v26 offset:49152
    ds_read_b64_tr_b16 v[160:161], v169 offset:28672
    ds_read_b64_tr_b16 v[162:163], v169 offset:29184
    ds_read_b128 v[156:159], v26 offset:53248
    v_mfma_f32_32x32x16_bf16 v[112:127], v[136:139], v[132:135], v[112:127]
    s_waitcnt lgkmcnt(4)
    v_mfma_f32_32x32x16_bf16 v[96:111], v[148:151], v[140:143], v[96:111]
    ds_read_b128 v[128:131], v27 offset:49152
    ds_read_b64_tr_b16 v[136:137], v169 offset:30720
    ds_read_b64_tr_b16 v[138:139], v169 offset:31232
    ds_read_b128 v[132:135], v27 offset:53248
    v_mfma_f32_32x32x16_bf16 v[112:127], v[148:151], v[144:147], v[112:127]
    s_waitcnt lgkmcnt(0)
    v_mfma_f32_32x32x16_bf16 v[96:111], v[160:163], v[152:155], v[96:111]
    v_add_u32 v24, 65536, v24
    v_add_u32 v25, 65536, v25
    v_add_u32 v26, 65536, v26
    v_add_u32 v27, 65536, v27
    s_barrier
    ds_read_b128 v[140:143], v24 offset:0
    ds_read_b64_tr_b16 v[148:149], v169 offset:32768
    ds_read_b64_tr_b16 v[150:151], v169 offset:33280
    ds_read_b128 v[144:147], v24 offset:4096
    v_mfma_f32_32x32x16_bf16 v[112:127], v[160:163], v[156:159], v[112:127]
    s_waitcnt lgkmcnt(4)
    v_mfma_f32_32x32x16_bf16 v[96:111], v[136:139], v[128:131], v[96:111]
    ds_read_b128 v[152:155], v25 offset:0
    ds_read_b64_tr_b16 v[160:161], v169 offset:34816
    ds_read_b64_tr_b16 v[162:163], v169 offset:35328
    ds_read_b128 v[156:159], v25 offset:4096
    v_mfma_f32_32x32x16_bf16 v[112:127], v[136:139], v[132:135], v[112:127]
    s_waitcnt lgkmcnt(4)
    v_mfma_f32_32x32x16_bf16 v[96:111], v[148:151], v[140:143], v[96:111]
    ds_read_b128 v[128:131], v26 offset:0
    ds_read_b64_tr_b16 v[136:137], v169 offset:36864
    ds_read_b64_tr_b16 v[138:139], v169 offset:37376
    ds_read_b128 v[132:135], v26 offset:4096
    v_mfma_f32_32x32x16_bf16 v[112:127], v[148:151], v[144:147], v[112:127]
    s_waitcnt lgkmcnt(4)
    v_mfma_f32_32x32x16_bf16 v[96:111], v[160:163], v[152:155], v[96:111]
    ds_read_b128 v[140:143], v27 offset:0
    ds_read_b64_tr_b16 v[148:149], v169 offset:38912
    ds_read_b64_tr_b16 v[150:151], v169 offset:39424
    ds_read_b128 v[144:147], v27 offset:4096
    v_mfma_f32_32x32x16_bf16 v[112:127], v[160:163], v[156:159], v[112:127]
    s_waitcnt lgkmcnt(4)
    v_mfma_f32_32x32x16_bf16 v[96:111], v[136:139], v[128:131], v[96:111]
    ds_read_b128 v[152:155], v24 offset:16384
    ds_read_b64_tr_b16 v[160:161], v169 offset:40960
    ds_read_b64_tr_b16 v[162:163], v169 offset:41472
    ds_read_b128 v[156:159], v24 offset:20480
    v_mfma_f32_32x32x16_bf16 v[112:127], v[136:139], v[132:135], v[112:127]
    s_waitcnt lgkmcnt(4)
    v_mfma_f32_32x32x16_bf16 v[96:111], v[148:151], v[140:143], v[96:111]
    ds_read_b128 v[128:131], v25 offset:16384
    ds_read_b64_tr_b16 v[136:137], v169 offset:43008
    ds_read_b64_tr_b16 v[138:139], v169 offset:43520
    ds_read_b128 v[132:135], v25 offset:20480
    v_mfma_f32_32x32x16_bf16 v[112:127], v[148:151], v[144:147], v[112:127]
    s_waitcnt lgkmcnt(4)
    v_mfma_f32_32x32x16_bf16 v[96:111], v[160:163], v[152:155], v[96:111]
    ds_read_b128 v[140:143], v26 offset:16384
    ds_read_b64_tr_b16 v[148:149], v169 offset:45056
    ds_read_b64_tr_b16 v[150:151], v169 offset:45568
    ds_read_b128 v[144:147], v26 offset:20480
    v_mfma_f32_32x32x16_bf16 v[112:127], v[160:163], v[156:159], v[112:127]
    s_waitcnt vmcnt(8)
    s_mov_b32 s53, 1000000
L_tagc_chk:
    v_readfirstlane_b32 s50, v174
    v_readfirstlane_b32 s51, v175
    s_nop 1
    s_cmp_lg_u64 s[50:51], 0
    s_cbranch_scc1 L_tagc_ok
    s_sub_u32 s53, s53, 1
    s_cbranch_scc1 L_tagc_ok
    global_load_dwordx2 v[174:175], v7, s[18:19] sc1
    s_waitcnt vmcnt(0)
    s_branch L_tagc_chk
L_tagc_ok:
    s_waitcnt vmcnt(0)
    v_mov_b32 v174, s50
    v_mov_b32 v175, s51
    s_mov_b64 exec, 1
    buffer_store_dwordx2 v[174:175], v7, s[36:39], s10 offen sc1
    s_mov_b64 exec, -1
    s_waitcnt lgkmcnt(4)
    v_mfma_f32_32x32x16_bf16 v[96:111], v[136:139], v[128:131], v[96:111]
    ds_read_b128 v[152:155], v27 offset:16384
    ds_read_b64_tr_b16 v[160:161], v169 offset:47104
    ds_read_b64_tr_b16 v[162:163], v169 offset:47616
    ds_read_b128 v[156:159], v27 offset:20480
    v_mfma_f32_32x32x16_bf16 v[112:127], v[136:139], v[132:135], v[112:127]
    s_waitcnt lgkmcnt(4)
    v_mfma_f32_32x32x16_bf16 v[96:111], v[148:151], v[140:143], v[96:111]
    ds_read_b128 v[40:43], v24 offset:32768
    ds_read_b128 v[44:47], v24 offset:36864
    ds_read_b128 v[56:59], v25 offset:32768
    ds_read_b128 v[60:63], v25 offset:36864
    v_mfma_f32_32x32x16_bf16 v[112:127], v[148:151], v[144:147], v[112:127]
    s_waitcnt lgkmcnt(4)
    v_mfma_f32_32x32x16_bf16 v[96:111], v[160:163], v[152:155], v[96:111]
    ds_read_b128 v[72:75], v26 offset:32768
    ds_read_b128 v[76:79], v26 offset:36864
    ds_read_b128 v[88:91], v27 offset:32768
    ds_read_b128 v[92:95], v27 offset:36864
    v_mfma_f32_32x32x16_bf16 v[112:127], v[160:163], v[156:159], v[112:127]
    s_waitcnt lgkmcnt(0)
    s_barrier
    ds_read_b64_tr_b16 v[164:165], v169 offset:0
    ds_read_b64_tr_b16 v[166:167], v169 offset:512
    ds_read_b64_tr_b16 v[128:129], v169 offset:2048
    ds_read_b64_tr_b16 v[130:131], v169 offset:2560
    ds_read_b64_tr_b16 v[132:133], v169 offset:4096
    ds_read_b64_tr_b16 v[134:135], v169 offset:4608
    ds_read_b64_tr_b16 v[136:137], v169 offset:6144
    ds_read_b64_tr_b16 v[138:139], v169 offset:6656
    s_waitcnt lgkmcnt(6)
    v_mfma_f32_32x32x16_bf16 v[96:111], v[164:167], v[40:43], v[96:111]
    ds_write_b128 v170, v[32:35] offset:0
    ds_write_b128 v170, v[36:39] offset:1024
    s_waitcnt lgkmcnt(6)
    v_mfma_f32_32x32x16_bf16 v[96:111], v[128:131], v[56:59], v[96:111]
    ds_write_b128 v171, v[48:51] offset:2048
    ds_write_b128 v171, v[52:55] offset:3072
    s_waitcnt lgkmcnt(6)
    v_mfma_f32_32x32x16_bf16 v[96:111], v[132:135], v[72:75], v[96:111]
    ds_write_b128 v170, v[64:67] offset:4096
    ds_write_b128 v170, v[68:71] offset:5120
    s_waitcnt lgkmcnt(6)
    v_mfma_f32_32x32x16_bf16 v[96:111], v[136:139], v[88:91], v[96:111]
    ds_write_b128 v171, v[80:83] offset:6144
    ds_write_b128 v171, v[84:87] offset:7168
    v_mfma_f32_32x32x16_bf16 v[112:127], v[164:167], v[44:47], v[112:127]
    v_mfma_f32_32x32x16_bf16 v[112:127], v[128:131], v[60:63], v[112:127]
    v_mfma_f32_32x32x16_bf16 v[112:127], v[132:135], v[76:79], v[112:127]
    v_mfma_f32_32x32x16_bf16 v[112:127], v[136:139], v[92:95], v[112:127]
    s_nop 7
    v_pk_mul_f32 v[96:97], v[96:97], s[60:61]
    v_pk_mul_f32 v[98:99], v[98:99], s[60:61]
    v_pk_mul_f32 v[100:101], v[100:101], s[60:61]
    v_pk_mul_f32 v[102:103], v[102:103], s[60:61]
    v_pk_mul_f32 v[104:105], v[104:105], s[60:61]
    v_pk_mul_f32 v[106:107], v[106:107], s[60:61]
    v_pk_mul_f32 v[108:109], v[108:109], s[60:61]
    v_pk_mul_f32 v[110:111], v[110:111], s[60:61]
    v_cvt_pk_bf16_f32 v8, v96, v97
    v_cvt_pk_bf16_f32 v9, v98, v99
    v_cvt_pk_bf16_f32 v10, v100, v101
    v_cvt_pk_bf16_f32 v11, v102, v103
    v_cvt_pk_bf16_f32 v12, v104, v105
    v_cvt_pk_bf16_f32 v13, v106, v107
    v_cvt_pk_bf16_f32 v14, v108, v109
    v_cvt_pk_bf16_f32 v15, v110, v111
    v_cndmask_b32 v14, 0, v14, vcc
    v_cndmask_b32 v15, 0, v15, vcc
    ds_write_b128 v172, v[8:11] offset:0
    ds_write_b128 v172, v[12:15] offset:1024
    v_pk_mul_f32 v[112:113], v[112:113], s[60:61]
    v_pk_mul_f32 v[114:115], v[114:115], s[60:61]
    v_pk_mul_f32 v[116:117], v[116:117], s[60:61]
    v_pk_mul_f32 v[118:119], v[118:119], s[60:61]
    v_pk_mul_f32 v[120:121], v[120:121], s[60:61]
    v_pk_mul_f32 v[122:123], v[122:123], s[60:61]
    v_pk_mul_f32 v[124:125], v[124:125], s[60:61]
    v_pk_mul_f32 v[126:127], v[126:127], s[60:61]
    v_cvt_pk_bf16_f32 v16, v112, v113
    v_cvt_pk_bf16_f32 v17, v114, v115
    v_cvt_pk_bf16_f32 v18, v116, v117
    v_cvt_pk_bf16_f32 v19, v118, v119
    v_cvt_pk_bf16_f32 v20, v120, v121
    v_cvt_pk_bf16_f32 v21, v122, v123
    v_cvt_pk_bf16_f32 v22, v124, v125
    v_cvt_pk_bf16_f32 v23, v126, v127
    v_cndmask_b32 v22, 0, v22, vcc
    v_cndmask_b32 v23, 0, v23, vcc
    ds_write_b128 v172, v[16:19] offset:2048
    ds_write_b128 v172, v[20:23] offset:3072
    s_waitcnt lgkmcnt(0)
    s_barrier
L_attn:
    s_mov_b64 exec, 0xffff
    buffer_load_dwordx2 v[250:251], v248, s[36:39], s9 offen sc1
    s_mov_b64 exec, -1
    ds_read_b128 v[8:11], v6 offset:0
    ds_read_b128 v[12:15], v6 offset:1024
    ds_read_b128 v[128:131], v5 offset:0
    ds_read_b128 v[132:135], v5 offset:1024
    ds_read_b128 v[16:19], v6 offset:2048
    ds_read_b128 v[20:23], v6 offset:3072
    ds_read_b128 v[24:27], v6 offset:4096
    ds_read_b128 v[28:31], v6 offset:5120
    ds_read_b128 v[32:35], v6 offset:6144
    ds_read_b128 v[36:39], v6 offset:7168
    ds_read_b128 v[152:155], v5 offset:2048
    ds_read_b128 v[156:159], v5 offset:3072
    s_waitcnt lgkmcnt(8)
    v_mfma_f32_32x32x16_bf16 v[64:79], v[128:131], v[8:11], 0
    v_mfma_f32_32x32x16_bf16 v[64:79], v[132:135], v[12:15], v[64:79]
    s_nop 10
    s_waitcnt lgkmcnt(0)
    s_setprio 3
    v_mfma_f32_32x32x16_bf16 v[80:95], v[128:131], v[16:19], 0
    v_exp_f32 v64, v64
    v_exp_f32 v65, v65
    v_exp_f32 v66, v66
    v_exp_f32 v67, v67
    v_mfma_f32_32x32x16_bf16 v[80:95], v[132:135], v[20:23], v[80:95]
    v_exp_f32 v68, v68
    v_exp_f32 v69, v69
    v_exp_f32 v70, v70
    v_exp_f32 v71, v71
    v_exp_f32 v72, v72
    v_exp_f32 v73, v73
    v_exp_f32 v74, v74
    v_exp_f32 v75, v75
    v_exp_f32 v76, v76
    v_exp_f32 v77, v77
    v_exp_f32 v78, v78
    v_exp_f32 v79, v79
    s_mov_b32 s53, 1000000
L_kvp_chk:
    s_waitcnt vmcnt(0)
    v_cmp_eq_u64 vcc, s[50:51], v[250:251]
    s_nop 1
    s_and_b32 s54, vcc_lo, 0xffff
    s_cmp_eq_u32 s54, 0xffff
    s_cbranch_scc1 L_kvp_ok
    s_sub_u32 s53, s53, 1
    s_cbranch_scc1 L_kvp_ok
    s_sleep 2
    s_mov_b64 exec, 0xffff
    buffer_load_dwordx2 v[250:251], v248, s[36:39], s9 offen sc1
    s_mov_b64 exec, -1
    s_branch L_kvp_chk
L_kvp_ok:
    s_add_u32 s6, s25, 1
    s_and_b32 s6, s6, 3
    s_and_b32 s5, s25, 8
    s_or_b32 s5, s5, s6
    s_lshl_b32 s6, s5, 14
    s_add_u32 s6, s6, s4
    buffer_load_dwordx4 v[136:139], v3, s[36:39], s6 offen offset:0 sc1
    buffer_load_dwordx4 v[140:143], v3, s[36:39], s6 offen offset:1024 sc1
    buffer_load_dwordx4 v[160:163], v3, s[36:39], s6 offen offset:2048 sc1
    buffer_load_dwordx4 v[164:167], v3, s[36:39], s6 offen offset:3072 sc1
    s_setprio 2
    v_mfma_f32_32x32x16_bf16 v[96:111], v[128:131], v[24:27], 0
    v_exp_f32 v80, v80
    v_exp_f32 v81, v81
    v_exp_f32 v82, v82
    v_exp_f32 v83, v83
    v_mfma_f32_32x32x16_bf16 v[96:111], v[132:135], v[28:31], v[96:111]
    v_exp_f32 v84, v84
    v_exp_f32 v85, v85
    v_exp_f32 v86, v86
    v_exp_f32 v87, v87
    v_smfmac_f32_32x32x32_bf16 v[176:191], v[152:155], v[64:71], v4
    v_exp_f32 v88, v88
    v_exp_f32 v89, v89
    v_exp_f32 v90, v90
    v_exp_f32 v91, v91
    v_smfmac_f32_32x32x32_bf16 v[176:191], v[156:159], v[72:79], v4
    v_exp_f32 v92, v92
    v_exp_f32 v93, v93
    v_exp_f32 v94, v94
    v_exp_f32 v95, v95
    s_setprio 1
    v_mfma_f32_32x32x16_bf16 v[112:127], v[128:131], v[32:35], 0
    v_exp_f32 v96, v96
    v_exp_f32 v97, v97
    v_exp_f32 v98, v98
    v_exp_f32 v99, v99
    s_add_u32 s6, s25, 2
    s_and_b32 s6, s6, 3
    s_and_b32 s5, s25, 8
    s_or_b32 s5, s5, s6
    s_lshl_b32 s6, s5, 14
    s_add_u32 s6, s6, s4
    v_mfma_f32_32x32x16_bf16 v[112:127], v[132:135], v[36:39], v[112:127]
    v_exp_f32 v100, v100
    v_exp_f32 v101, v101
    v_exp_f32 v102, v102
    v_exp_f32 v103, v103
    buffer_load_dwordx4 v[144:147], v3, s[36:39], s6 offen offset:0 sc1
    buffer_load_dwordx4 v[148:151], v3, s[36:39], s6 offen offset:1024 sc1
    v_smfmac_f32_32x32x32_bf16 v[192:207], v[152:155], v[80:87], v4
    v_exp_f32 v104, v104
    v_exp_f32 v105, v105
    v_exp_f32 v106, v106
    v_exp_f32 v107, v107
    buffer_load_dwordx4 v[168:171], v3, s[36:39], s6 offen offset:2048 sc1
    buffer_load_dwordx4 v[172:175], v3, s[36:39], s6 offen offset:3072 sc1
    v_smfmac_f32_32x32x32_bf16 v[192:207], v[156:159], v[88:95], v4
    v_exp_f32 v108, v108
    v_exp_f32 v109, v109
    v_exp_f32 v110, v110
    v_exp_f32 v111, v111
    s_setprio 0
    v_smfmac_f32_32x32x32_bf16 v[208:223], v[152:155], v[96:103], v4
    v_exp_f32 v112, v112
    v_exp_f32 v113, v113
    v_exp_f32 v114, v114
    v_exp_f32 v115, v115
    v_exp_f32 v116, v116
    v_smfmac_f32_32x32x32_bf16 v[208:223], v[156:159], v[104:111], v4
    v_exp_f32 v117, v117
    v_exp_f32 v118, v118
    v_exp_f32 v119, v119
    v_exp_f32 v120, v120
    s_waitcnt vmcnt(6)
    v_mfma_f32_32x32x16_bf16 v[64:79], v[136:139], v[8:11], 0
    v_exp_f32 v121, v121
    v_exp_f32 v122, v122
    v_mfma_f32_32x32x16_bf16 v[64:79], v[140:143], v[12:15], v[64:79]
    v_exp_f32 v123, v123
    v_exp_f32 v124, v124
    v_exp_f32 v125, v125
    v_exp_f32 v126, v126
    v_exp_f32 v127, v127
    s_add_u32 s6, s25, 3
    s_and_b32 s6, s6, 3
    s_and_b32 s5, s25, 8
    s_or_b32 s5, s5, s6
    s_lshl_b32 s6, s5, 14
    s_add_u32 s6, s6, s4
    s_setprio 3
    v_mfma_f32_32x32x16_bf16 v[80:95], v[136:139], v[16:19], 0
    v_exp_f32 v64, v64
    v_exp_f32 v65, v65
    v_exp_f32 v66, v66
    v_exp_f32 v67, v67
    buffer_load_dwordx4 v[128:131], v3, s[36:39], s6 offen offset:0 sc1
    buffer_load_dwordx4 v[132:135], v3, s[36:39], s6 offen offset:1024 sc1
    v_mfma_f32_32x32x16_bf16 v[80:95], v[140:143], v[20:23], v[80:95]
    v_exp_f32 v68, v68
    v_exp_f32 v69, v69
    v_exp_f32 v70, v70
    v_exp_f32 v71, v71
    v_smfmac_f32_32x32x32_bf16 v[224:239], v[152:155], v[112:119], v4
    v_exp_f32 v72, v72
    v_exp_f32 v73, v73
    v_exp_f32 v74, v74
    v_exp_f32 v75, v75
    v_smfmac_f32_32x32x32_bf16 v[224:239], v[156:159], v[120:127], v4
    v_exp_f32 v76, v76
    v_exp_f32 v77, v77
    v_exp_f32 v78, v78
    v_exp_f32 v79, v79
    buffer_load_dwordx4 v[152:155], v3, s[36:39], s6 offen offset:2048 sc1
    buffer_load_dwordx4 v[156:159], v3, s[36:39], s6 offen offset:3072 sc1
    s_setprio 2
    s_waitcnt vmcnt(8)
    v_mfma_f32_32x32x16_bf16 v[96:111], v[136:139], v[24:27], 0
    v_exp_f32 v80, v80
    v_exp_f32 v81, v81
    v_exp_f32 v82, v82
    v_exp_f32 v83, v83
    v_mfma_f32_32x32x16_bf16 v[96:111], v[140:143], v[28:31], v[96:111]
    v_exp_f32 v84, v84
    v_exp_f32 v85, v85
    v_exp_f32 v86, v86
    v_exp_f32 v87, v87
    v_smfmac_f32_32x32x32_bf16 v[176:191], v[160:163], v[64:71], v4
    v_exp_f32 v88, v88
    v_exp_f32 v89, v89
    v_exp_f32 v90, v90
    v_exp_f32 v91, v91
    v_smfmac_f32_32x32x32_bf16 v[176:191], v[164:167], v[72:79], v4
    v_exp_f32 v92, v92
    v_exp_f32 v93, v93
    v_exp_f32 v94, v94
    v_exp_f32 v95, v95
    s_setprio 1
    v_mfma_f32_32x32x16_bf16 v[112:127], v[136:139], v[32:35], 0
    v_exp_f32 v96, v96
    v_exp_f32 v97, v97
    v_exp_f32 v98, v98
    v_exp_f32 v99, v99
    v_mfma_f32_32x32x16_bf16 v[112:127], v[140:143], v[36:39], v[112:127]
    v_exp_f32 v100, v100
    v_exp_f32 v101, v101
    v_exp_f32 v102, v102
    v_exp_f32 v103, v103
    v_smfmac_f32_32x32x32_bf16 v[192:207], v[160:163], v[80:87], v4
    v_exp_f32 v104, v104
    v_exp_f32 v105, v105
    v_exp_f32 v106, v106
    v_exp_f32 v107, v107
    s_and_b32 s6, s25, 11
    s_and_b32 s5, s25, 8
    s_add_u32 s5, s5, 4
    s_bitcmp1_b32 s25, 2
    s_cselect_b32 s6, s6, s5
    s_subb_u32 s5, s5, 0
    s_lshl_b32 s6, s6, 14
    s_add_u32 s6, s6, s4
    v_smfmac_f32_32x32x32_bf16 v[192:207], v[164:167], v[88:95], v4
    v_exp_f32 v108, v108
    v_exp_f32 v109, v109
    v_exp_f32 v110, v110
    v_exp_f32 v111, v111
    buffer_load_dwordx4 v[136:139], v3, s[36:39], s6 offen offset:0 sc1
    buffer_load_dwordx4 v[140:143], v3, s[36:39], s6 offen offset:1024 sc1
    s_setprio 0
    s_waitcnt vmcnt(8)
    v_mfma_f32_32x32x16_bf16 v[64:79], v[144:147], v[8:11], 0
    v_exp_f32 v112, v112
    v_exp_f32 v113, v113
    v_exp_f32 v114, v114
    v_exp_f32 v115, v115
    v_mfma_f32_32x32x16_bf16 v[64:79], v[148:151], v[12:15], v[64:79]
    v_exp_f32 v116, v116
    v_exp_f32 v117, v117
    v_exp_f32 v118, v118
    v_exp_f32 v119, v119
    v_smfmac_f32_32x32x32_bf16 v[208:223], v[160:163], v[96:103], v4
    v_exp_f32 v120, v120
    v_exp_f32 v121, v121
    v_exp_f32 v122, v122
    v_exp_f32 v123, v123
    v_smfmac_f32_32x32x32_bf16 v[208:223], v[164:167], v[104:111], v4
    v_exp_f32 v124, v124
    v_exp_f32 v125, v125
    v_exp_f32 v126, v126
    v_exp_f32 v127, v127
    v_mov_b32 v40, -1
    v_mov_b32 v41, -1
    v_mov_b32 v42, -1
    v_mov_b32 v43, -1
    buffer_store_dwordx4 v[40:43], v3, s[36:39], s14 offen sc1
    buffer_store_dwordx4 v[40:43], v3, s[36:39], s14 offen offset:1024 sc1
    s_barrier
    s_mov_b32 s69, s4
.p2align 6
L_loop:
    s_setprio 3
    v_mfma_f32_32x32x16_bf16 v[80:95], v[144:147], v[16:19], 0
    v_exp_f32 v64, v64
    v_exp_f32 v65, v65
    v_exp_f32 v66, v66
    v_exp_f32 v67, v67
    v_mfma_f32_32x32x16_bf16 v[80:95], v[148:151], v[20:23], v[80:95]
    v_exp_f32 v68, v68
    v_exp_f32 v69, v69
    v_exp_f32 v70, v70
    v_exp_f32 v71, v71
    v_smfmac_f32_32x32x32_bf16 v[224:239], v[160:163], v[112:119], v4
    v_exp_f32 v72, v72
    v_exp_f32 v73, v73
    v_exp_f32 v74, v74
    v_exp_f32 v75, v75
    v_smfmac_f32_32x32x32_bf16 v[224:239], v[164:167], v[120:127], v4
    v_exp_f32 v76, v76
    v_exp_f32 v77, v77
    v_exp_f32 v78, v78
    v_exp_f32 v79, v79
    buffer_load_dwordx4 v[160:163], v3, s[36:39], s6 offen offset:2048 sc1
    buffer_load_dwordx4 v[164:167], v3, s[36:39], s6 offen offset:3072 sc1
    s_setprio 2
    s_waitcnt vmcnt(8)
    v_mfma_f32_32x32x16_bf16 v[96:111], v[144:147], v[24:27], 0
    v_exp_f32 v80, v80
    v_exp_f32 v81, v81
    v_exp_f32 v82, v82
    v_exp_f32 v83, v83
    v_mfma_f32_32x32x16_bf16 v[96:111], v[148:151], v[28:31], v[96:111]
    v_exp_f32 v84, v84
    v_exp_f32 v85, v85
    v_exp_f32 v86, v86
    v_exp_f32 v87, v87
    s_mov_b32 m0, s13
    s_add_u32 s13, s13, 8192
    buffer_load_dwordx4 v241, s[40:43], s11 offen sc1 lds
    s_add_u32 s11, s11, 57344
    v_smfmac_f32_32x32x32_bf16 v[176:191], v[168:171], v[64:71], v4
    v_exp_f32 v88, v88
    v_exp_f32 v89, v89
    v_exp_f32 v90, v90
    v_exp_f32 v91, v91
    v_smfmac_f32_32x32x32_bf16 v[176:191], v[172:175], v[72:79], v4
    v_exp_f32 v92, v92
    v_exp_f32 v93, v93
    v_exp_f32 v94, v94
    v_exp_f32 v95, v95
    s_setprio 1
    v_mfma_f32_32x32x16_bf16 v[112:127], v[144:147], v[32:35], 0
    v_exp_f32 v96, v96
    v_exp_f32 v97, v97
    v_exp_f32 v98, v98
    v_exp_f32 v99, v99
    v_mfma_f32_32x32x16_bf16 v[112:127], v[148:151], v[36:39], v[112:127]
    v_exp_f32 v100, v100
    v_exp_f32 v101, v101
    v_exp_f32 v102, v102
    v_exp_f32 v103, v103
    s_add_u32 s5, s5, 1
    s_and_b32 s5, s5, 15
    s_cmp_eq_u32 s5, s25
    s_addc_u32 s5, s5, 0
    s_and_b32 s5, s5, 15
    s_lshl_b32 s6, s5, 14
    s_add_u32 s6, s6, s69
    v_smfmac_f32_32x32x32_bf16 v[192:207], v[168:171], v[80:87], v4
    v_exp_f32 v104, v104
    v_exp_f32 v105, v105
    v_exp_f32 v106, v106
    v_exp_f32 v107, v107
    v_smfmac_f32_32x32x32_bf16 v[192:207], v[172:175], v[88:95], v4
    v_exp_f32 v108, v108
    v_exp_f32 v109, v109
    v_exp_f32 v110, v110
    v_exp_f32 v111, v111
    buffer_load_dwordx4 v[144:147], v3, s[36:39], s6 offen offset:0 sc1
    buffer_load_dwordx4 v[148:151], v3, s[36:39], s6 offen offset:1024 sc1
    s_setprio 0
    s_waitcnt vmcnt(8)
    v_mfma_f32_32x32x16_bf16 v[64:79], v[128:131], v[8:11], 0
    v_exp_f32 v112, v112
    v_exp_f32 v113, v113
    v_exp_f32 v114, v114
    v_exp_f32 v115, v115
    v_mfma_f32_32x32x16_bf16 v[64:79], v[132:135], v[12:15], v[64:79]
    v_exp_f32 v116, v116
    v_exp_f32 v117, v117
    v_exp_f32 v118, v118
    v_exp_f32 v119, v119
    v_smfmac_f32_32x32x32_bf16 v[208:223], v[168:171], v[96:103], v4
    v_exp_f32 v120, v120
    v_exp_f32 v121, v121
    v_exp_f32 v122, v122
    v_exp_f32 v123, v123
    v_smfmac_f32_32x32x32_bf16 v[208:223], v[172:175], v[104:111], v4
    v_exp_f32 v124, v124
    v_exp_f32 v125, v125
    v_exp_f32 v126, v126
    v_exp_f32 v127, v127
    s_setprio 3
    v_mfma_f32_32x32x16_bf16 v[80:95], v[128:131], v[16:19], 0
    v_exp_f32 v64, v64
    v_exp_f32 v65, v65
    v_exp_f32 v66, v66
    v_exp_f32 v67, v67
    v_mfma_f32_32x32x16_bf16 v[80:95], v[132:135], v[20:23], v[80:95]
    v_exp_f32 v68, v68
    v_exp_f32 v69, v69
    v_exp_f32 v70, v70
    v_exp_f32 v71, v71
    v_smfmac_f32_32x32x32_bf16 v[224:239], v[168:171], v[112:119], v4
    v_exp_f32 v72, v72
    v_exp_f32 v73, v73
    v_exp_f32 v74, v74
    v_exp_f32 v75, v75
    v_smfmac_f32_32x32x32_bf16 v[224:239], v[172:175], v[120:127], v4
    v_exp_f32 v76, v76
    v_exp_f32 v77, v77
    v_exp_f32 v78, v78
    v_exp_f32 v79, v79
    buffer_load_dwordx4 v[168:171], v3, s[36:39], s6 offen offset:2048 sc1
    buffer_load_dwordx4 v[172:175], v3, s[36:39], s6 offen offset:3072 sc1
    s_setprio 2
    s_waitcnt vmcnt(8)
    v_mfma_f32_32x32x16_bf16 v[96:111], v[128:131], v[24:27], 0
    v_exp_f32 v80, v80
    v_exp_f32 v81, v81
    v_exp_f32 v82, v82
    v_exp_f32 v83, v83
    v_mfma_f32_32x32x16_bf16 v[96:111], v[132:135], v[28:31], v[96:111]
    v_exp_f32 v84, v84
    v_exp_f32 v85, v85
    v_exp_f32 v86, v86
    v_exp_f32 v87, v87
    s_mov_b32 m0, s13
    s_add_u32 s13, s13, 8192
    buffer_load_dwordx4 v241, s[40:43], s11 offen sc1 lds
    s_add_u32 s11, s11, 57344
    v_smfmac_f32_32x32x32_bf16 v[176:191], v[152:155], v[64:71], v4
    v_exp_f32 v88, v88
    v_exp_f32 v89, v89
    v_exp_f32 v90, v90
    v_exp_f32 v91, v91
    v_smfmac_f32_32x32x32_bf16 v[176:191], v[156:159], v[72:79], v4
    v_exp_f32 v92, v92
    v_exp_f32 v93, v93
    v_exp_f32 v94, v94
    v_exp_f32 v95, v95
    s_setprio 1
    v_mfma_f32_32x32x16_bf16 v[112:127], v[128:131], v[32:35], 0
    v_exp_f32 v96, v96
    v_exp_f32 v97, v97
    v_exp_f32 v98, v98
    v_exp_f32 v99, v99
    v_mfma_f32_32x32x16_bf16 v[112:127], v[132:135], v[36:39], v[112:127]
    v_exp_f32 v100, v100
    v_exp_f32 v101, v101
    v_exp_f32 v102, v102
    v_exp_f32 v103, v103
    s_add_u32 s5, s5, 1
    s_and_b32 s5, s5, 15
    s_cmp_eq_u32 s5, s25
    s_addc_u32 s5, s5, 0
    s_and_b32 s5, s5, 15
    s_lshl_b32 s6, s5, 14
    s_add_u32 s6, s6, s69
    v_smfmac_f32_32x32x32_bf16 v[192:207], v[152:155], v[80:87], v4
    v_exp_f32 v104, v104
    v_exp_f32 v105, v105
    v_exp_f32 v106, v106
    v_exp_f32 v107, v107
    v_smfmac_f32_32x32x32_bf16 v[192:207], v[156:159], v[88:95], v4
    v_exp_f32 v108, v108
    v_exp_f32 v109, v109
    v_exp_f32 v110, v110
    v_exp_f32 v111, v111
    buffer_load_dwordx4 v[128:131], v3, s[36:39], s6 offen offset:0 sc1
    buffer_load_dwordx4 v[132:135], v3, s[36:39], s6 offen offset:1024 sc1
    s_setprio 0
    s_waitcnt vmcnt(8)
    v_mfma_f32_32x32x16_bf16 v[64:79], v[136:139], v[8:11], 0
    v_exp_f32 v112, v112
    v_exp_f32 v113, v113
    v_exp_f32 v114, v114
    v_exp_f32 v115, v115
    v_mfma_f32_32x32x16_bf16 v[64:79], v[140:143], v[12:15], v[64:79]
    v_exp_f32 v116, v116
    v_exp_f32 v117, v117
    v_exp_f32 v118, v118
    v_exp_f32 v119, v119
    v_smfmac_f32_32x32x32_bf16 v[208:223], v[152:155], v[96:103], v4
    v_exp_f32 v120, v120
    v_exp_f32 v121, v121
    v_exp_f32 v122, v122
    v_exp_f32 v123, v123
    v_smfmac_f32_32x32x32_bf16 v[208:223], v[156:159], v[104:111], v4
    v_exp_f32 v124, v124
    v_exp_f32 v125, v125
    v_exp_f32 v126, v126
    v_exp_f32 v127, v127
    s_setprio 3
    v_mfma_f32_32x32x16_bf16 v[80:95], v[136:139], v[16:19], 0
    v_exp_f32 v64, v64
    v_exp_f32 v65, v65
    v_exp_f32 v66, v66
    v_exp_f32 v67, v67
    v_mfma_f32_32x32x16_bf16 v[80:95], v[140:143], v[20:23], v[80:95]
    v_exp_f32 v68, v68
    v_exp_f32 v69, v69
    v_exp_f32 v70, v70
    v_exp_f32 v71, v71
    v_smfmac_f32_32x32x32_bf16 v[224:239], v[152:155], v[112:119], v4
    v_exp_f32 v72, v72
    v_exp_f32 v73, v73
    v_exp_f32 v74, v74
    v_exp_f32 v75, v75
    v_smfmac_f32_32x32x32_bf16 v[224:239], v[156:159], v[120:127], v4
    v_exp_f32 v76, v76
    v_exp_f32 v77, v77
    v_exp_f32 v78, v78
    v_exp_f32 v79, v79
    buffer_load_dwordx4 v[152:155], v3, s[36:39], s6 offen offset:2048 sc1
    buffer_load_dwordx4 v[156:159], v3, s[36:39], s6 offen offset:3072 sc1
    s_setprio 2
    s_waitcnt vmcnt(8)
    v_mfma_f32_32x32x16_bf16 v[96:111], v[136:139], v[24:27], 0
    v_exp_f32 v80, v80
    v_exp_f32 v81, v81
    v_exp_f32 v82, v82
    v_exp_f32 v83, v83
    v_mfma_f32_32x32x16_bf16 v[96:111], v[140:143], v[28:31], v[96:111]
    v_exp_f32 v84, v84
    v_exp_f32 v85, v85
    v_exp_f32 v86, v86
    v_exp_f32 v87, v87
    s_cmp_eq_u32 s68, 3
    s_cselect_b32 s69, 1073741824, s4
    v_smfmac_f32_32x32x32_bf16 v[176:191], v[160:163], v[64:71], v4
    v_exp_f32 v88, v88
    v_exp_f32 v89, v89
    v_exp_f32 v90, v90
    v_exp_f32 v91, v91
    v_smfmac_f32_32x32x32_bf16 v[176:191], v[164:167], v[72:79], v4
    v_exp_f32 v92, v92
    v_exp_f32 v93, v93
    v_exp_f32 v94, v94
    v_exp_f32 v95, v95
    s_setprio 1
    v_mfma_f32_32x32x16_bf16 v[112:127], v[136:139], v[32:35], 0
    v_exp_f32 v96, v96
    v_exp_f32 v97, v97
    v_exp_f32 v98, v98
    v_exp_f32 v99, v99
    v_mfma_f32_32x32x16_bf16 v[112:127], v[140:143], v[36:39], v[112:127]
    v_exp_f32 v100, v100
    v_exp_f32 v101, v101
    v_exp_f32 v102, v102
    v_exp_f32 v103, v103
    s_add_u32 s5, s5, 1
    s_and_b32 s5, s5, 15
    s_cmp_eq_u32 s5, s25
    s_addc_u32 s5, s5, 0
    s_and_b32 s5, s5, 15
    s_lshl_b32 s6, s5, 14
    s_add_u32 s6, s6, s69
    v_smfmac_f32_32x32x32_bf16 v[192:207], v[160:163], v[80:87], v4
    v_exp_f32 v104, v104
    v_exp_f32 v105, v105
    v_exp_f32 v106, v106
    v_exp_f32 v107, v107
    v_smfmac_f32_32x32x32_bf16 v[192:207], v[164:167], v[88:95], v4
    v_exp_f32 v108, v108
    v_exp_f32 v109, v109
    v_exp_f32 v110, v110
    v_exp_f32 v111, v111
    buffer_load_dwordx4 v[136:139], v3, s[36:39], s6 offen offset:0 sc1
    buffer_load_dwordx4 v[140:143], v3, s[36:39], s6 offen offset:1024 sc1
    s_setprio 0
    s_waitcnt vmcnt(8)
    v_mfma_f32_32x32x16_bf16 v[64:79], v[144:147], v[8:11], 0
    v_exp_f32 v112, v112
    v_exp_f32 v113, v113
    v_exp_f32 v114, v114
    v_exp_f32 v115, v115
    v_mfma_f32_32x32x16_bf16 v[64:79], v[148:151], v[12:15], v[64:79]
    v_exp_f32 v116, v116
    v_exp_f32 v117, v117
    v_exp_f32 v118, v118
    v_exp_f32 v119, v119
    v_smfmac_f32_32x32x32_bf16 v[208:223], v[160:163], v[96:103], v4
    v_exp_f32 v120, v120
    v_exp_f32 v121, v121
    v_exp_f32 v122, v122
    v_exp_f32 v123, v123
    v_smfmac_f32_32x32x32_bf16 v[208:223], v[164:167], v[104:111], v4
    v_exp_f32 v124, v124
    v_exp_f32 v125, v125
    v_exp_f32 v126, v126
    v_exp_f32 v127, v127
    s_add_u32 s68, s68, 1
    s_cmp_lt_u32 s68, 4
    s_cbranch_scc1 L_loop
    s_setprio 3
    s_waitcnt vmcnt(4)
    v_mfma_f32_32x32x16_bf16 v[80:95], v[128:131], v[8:11], 0
    v_exp_f32 v64, v64
    v_exp_f32 v65, v65
    v_exp_f32 v66, v66
    v_exp_f32 v67, v67
    v_mfma_f32_32x32x16_bf16 v[80:95], v[132:135], v[12:15], v[80:95]
    v_exp_f32 v68, v68
    v_exp_f32 v69, v69
    v_exp_f32 v70, v70
    v_exp_f32 v71, v71
    v_smfmac_f32_32x32x32_bf16 v[224:239], v[160:163], v[112:119], v4
    v_exp_f32 v72, v72
    v_exp_f32 v73, v73
    v_exp_f32 v74, v74
    v_exp_f32 v75, v75
    v_smfmac_f32_32x32x32_bf16 v[224:239], v[164:167], v[120:127], v4
    v_exp_f32 v76, v76
    v_exp_f32 v77, v77
    v_exp_f32 v78, v78
    v_exp_f32 v79, v79
    v_mov_b32 v252, s50
    v_mov_b32 v253, s51
    s_mov_b64 exec, 1
    buffer_store_dwordx2 v[252:253], v7, s[36:39], s15 offen sc1
    s_mov_b64 exec, -1
    v_mfma_f32_32x32x16_bf16 v[96:111], v[144:147], v[16:19], 0
    v_exp_f32 v80, v80
    v_exp_f32 v81, v81
    v_exp_f32 v82, v82
    v_exp_f32 v83, v83
    v_mfma_f32_32x32x16_bf16 v[96:111], v[148:151], v[20:23], v[96:111]
    v_exp_f32 v84, v84
    v_exp_f32 v85, v85
    v_exp_f32 v86, v86
    v_exp_f32 v87, v87
    v_smfmac_f32_32x32x32_bf16 v[176:191], v[168:171], v[64:71], v4
    v_exp_f32 v88, v88
    v_exp_f32 v89, v89
    v_exp_f32 v90, v90
    v_exp_f32 v91, v91
    v_smfmac_f32_32x32x32_bf16 v[176:191], v[172:175], v[72:79], v4
    v_exp_f32 v92, v92
    v_exp_f32 v93, v93
    v_exp_f32 v94, v94
    v_exp_f32 v95, v95
    s_setprio 2
    s_waitcnt vmcnt(3)
    v_mfma_f32_32x32x16_bf16 v[112:127], v[128:131], v[16:19], 0
    v_exp_f32 v96, v96
    v_exp_f32 v97, v97
    v_exp_f32 v98, v98
    v_exp_f32 v99, v99
    v_mfma_f32_32x32x16_bf16 v[112:127], v[132:135], v[20:23], v[112:127]
    v_exp_f32 v100, v100
    v_exp_f32 v101, v101
    v_exp_f32 v102, v102
    v_exp_f32 v103, v103
    v_smfmac_f32_32x32x32_bf16 v[176:191], v[152:155], v[80:87], v4
    v_exp_f32 v104, v104
    v_exp_f32 v105, v105
    v_exp_f32 v106, v106
    v_exp_f32 v107, v107
    v_smfmac_f32_32x32x32_bf16 v[176:191], v[156:159], v[88:95], v4
    v_exp_f32 v108, v108
    v_exp_f32 v109, v109
    v_exp_f32 v110, v110
    v_exp_f32 v111, v111
    s_setprio 1
    v_mfma_f32_32x32x16_bf16 v[64:79], v[144:147], v[24:27], 0
    v_exp_f32 v112, v112
    v_exp_f32 v113, v113
    v_exp_f32 v114, v114
    v_exp_f32 v115, v115
    v_mfma_f32_32x32x16_bf16 v[64:79], v[148:151], v[28:31], v[64:79]
    v_exp_f32 v116, v116
    v_exp_f32 v117, v117
    v_exp_f32 v118, v118
    v_exp_f32 v119, v119
    s_cmp_eq_u32 s100, 0
    s_cbranch_scc1 L_ns0
    s_sub_u32 s53, s8, 4096
    s_cmp_lt_u32 s100, 0
    s_cselect_b32 s53, s8, s53
    v_add_u32 v242, s53, v243
    ds_write_b128 v242, v[176:179] offset:0
    ds_write_b128 v242, v[180:183] offset:1024
    ds_write_b128 v242, v[184:187] offset:2048
    ds_write_b128 v242, v[188:191] offset:3072
L_ns0:
    v_smfmac_f32_32x32x32_bf16 v[192:207], v[168:171], v[96:103], v4
    v_exp_f32 v120, v120
    v_exp_f32 v121, v121
    v_exp_f32 v122, v122
    v_exp_f32 v123, v123
    v_smfmac_f32_32x32x32_bf16 v[192:207], v[172:175], v[104:111], v4
    v_exp_f32 v124, v124
    v_exp_f32 v125, v125
    v_exp_f32 v126, v126
    v_exp_f32 v127, v127
    s_setprio 0
    v_mfma_f32_32x32x16_bf16 v[80:95], v[128:131], v[24:27], 0
    v_exp_f32 v64, v64
    v_exp_f32 v65, v65
    v_exp_f32 v66, v66
    v_exp_f32 v67, v67
    v_mfma_f32_32x32x16_bf16 v[80:95], v[132:135], v[28:31], v[80:95]
    v_exp_f32 v68, v68
    v_exp_f32 v69, v69
    v_exp_f32 v70, v70
    v_exp_f32 v71, v71
    v_smfmac_f32_32x32x32_bf16 v[192:207], v[152:155], v[112:119], v4
    v_exp_f32 v72, v72
    v_exp_f32 v73, v73
    v_exp_f32 v74, v74
    v_exp_f32 v75, v75
    v_smfmac_f32_32x32x32_bf16 v[192:207], v[156:159], v[120:127], v4
    v_exp_f32 v76, v76
    v_exp_f32 v77, v77
    v_exp_f32 v78, v78
    v_exp_f32 v79, v79
    s_setprio 3
    s_nop 0
    s_cmp_eq_u32 s100, 1
    s_cbranch_scc1 L_ns1
    s_sub_u32 s53, s8, 4096
    s_cmp_lt_u32 s100, 1
    s_cselect_b32 s53, s8, s53
    v_add_u32 v242, s53, v243
    ds_write_b128 v242, v[192:195] offset:12288
    ds_write_b128 v242, v[196:199] offset:13312
    ds_write_b128 v242, v[200:203] offset:14336
    ds_write_b128 v242, v[204:207] offset:15360
L_ns1:
    s_waitcnt vmcnt(0) lgkmcnt(0)
    s_barrier
    s_cmp_eq_u32 s100, 0
    s_cbranch_scc1 L_k0
    s_cmp_eq_u32 s100, 1
    s_cbranch_scc0 L_x0_done
    ds_read_b128 v[40:43], v243 offset:12288
    ds_read_b128 v[44:47], v243 offset:13312
    ds_read_b128 v[48:51], v243 offset:14336
    ds_read_b128 v[52:55], v243 offset:15360
    ds_read_b128 v[136:139], v243 offset:16384
    ds_read_b128 v[140:143], v243 offset:17408
    ds_read_b128 v[160:163], v243 offset:18432
    ds_read_b128 v[164:167], v243 offset:19456
    s_waitcnt lgkmcnt(4)
    v_pk_add_f32 v[192:193], v[192:193], v[40:41]
    v_pk_add_f32 v[194:195], v[194:195], v[42:43]
    v_pk_add_f32 v[196:197], v[196:197], v[44:45]
    v_pk_add_f32 v[198:199], v[198:199], v[46:47]
    v_pk_add_f32 v[200:201], v[200:201], v[48:49]
    v_pk_add_f32 v[202:203], v[202:203], v[50:51]
    v_pk_add_f32 v[204:205], v[204:205], v[52:53]
    v_pk_add_f32 v[206:207], v[206:207], v[54:55]
    ds_read_b128 v[40:43], v243 offset:20480
    ds_read_b128 v[44:47], v243 offset:21504
    ds_read_b128 v[48:51], v243 offset:22528
    ds_read_b128 v[52:55], v243 offset:23552
    s_waitcnt lgkmcnt(4)
    v_pk_add_f32 v[192:193], v[192:193], v[136:137]
    v_pk_add_f32 v[194:195], v[194:195], v[138:139]
    v_pk_add_f32 v[196:197], v[196:197], v[140:141]
    v_pk_add_f32 v[198:199], v[198:199], v[142:143]
    v_pk_add_f32 v[200:201], v[200:201], v[160:161]
    v_pk_add_f32 v[202:203], v[202:203], v[162:163]
    v_pk_add_f32 v[204:205], v[204:205], v[164:165]
    v_pk_add_f32 v[206:207], v[206:207], v[166:167]
    s_waitcnt lgkmcnt(0)
    v_pk_add_f32 v[192:193], v[192:193], v[40:41]
    v_pk_add_f32 v[194:195], v[194:195], v[42:43]
    v_pk_add_f32 v[196:197], v[196:197], v[44:45]
    v_pk_add_f32 v[198:199], v[198:199], v[46:47]
    v_pk_add_f32 v[200:201], v[200:201], v[48:49]
    v_pk_add_f32 v[202:203], v[202:203], v[50:51]
    v_pk_add_f32 v[204:205], v[204:205], v[52:53]
    v_pk_add_f32 v[206:207], v[206:207], v[54:55]
    v_mov_b32 v56, v204
    v_mov_b32 v57, v204
    s_mov_b32 s54, 0x2f800000
    s_mov_b32 s62, 0x57800000
    v_permlane32_swap_b32 v56, v57
    v_pk_mul_f32 v[60:61], v[192:193], 0 op_sel_hi:[1,0]
    v_pk_mul_f32 v[62:63], v[194:195], 0 op_sel_hi:[1,0]
    v_rcp_f32 v58, v57
    v_pk_fma_f32 v[60:61], v[196:197], 0, v[60:61] op_sel_hi:[1,0,1]
    v_pk_fma_f32 v[62:63], v[198:199], 0, v[62:63] op_sel_hi:[1,0,1]
    v_pk_fma_f32 v[60:61], v[200:201], 0, v[60:61] op_sel_hi:[1,0,1]
    v_pk_fma_f32 v[62:63], v[202:203], 0, v[62:63] op_sel_hi:[1,0,1]
    v_pk_fma_f32 v[60:61], v[204:205], 0, v[60:61] op_sel_hi:[1,0,1]
    v_pk_fma_f32 v[62:63], v[206:207], 0, v[62:63] op_sel_hi:[1,0,1]
    v_pk_add_f32 v[60:61], v[60:61], v[62:63]
    v_add_f32 v60, v60, v61
    v_add_f32 v60, v60, v57
    v_cmp_ge_f32 vcc, v60, s54
    v_cmp_le_f32 s[56:57], v60, s62
    s_nop 1
    s_and_b64 s[56:57], s[56:57], vcc
    s_cmp_eq_u64 s[56:57], -1
    s_cselect_b32 s98, 0, 1
    s_cbranch_scc0 L_x0_done
    v_cmp_gt_u32 vcc, 32, v2
    v_pk_mul_f32 v[192:193], v[192:193], v[58:59] op_sel_hi:[1,0]
    v_pk_mul_f32 v[194:195], v[194:195], v[58:59] op_sel_hi:[1,0]
    v_pk_mul_f32 v[196:197], v[196:197], v[58:59] op_sel_hi:[1,0]
    v_pk_mul_f32 v[198:199], v[198:199], v[58:59] op_sel_hi:[1,0]
    v_pk_mul_f32 v[200:201], v[200:201], v[58:59] op_sel_hi:[1,0]
    v_pk_mul_f32 v[202:203], v[202:203], v[58:59] op_sel_hi:[1,0]
    v_pk_mul_f32 v[204:205], v[204:205], v[58:59] op_sel_hi:[1,0]
    v_pk_mul_f32 v[206:207], v[206:207], v[58:59] op_sel_hi:[1,0]
    v_cvt_pk_bf16_f32 v40, v192, v193
    v_cvt_pk_bf16_f32 v41, v194, v195
    v_cvt_pk_bf16_f32 v42, v196, v197
    v_cvt_pk_bf16_f32 v43, v198, v199
    buffer_store_dwordx4 v[40:43], v3, s[36:39], s14 offen sc1
    v_cvt_pk_bf16_f32 v44, v200, v201
    v_cvt_pk_bf16_f32 v45, v202, v203
    v_cvt_pk_bf16_f32 v46, v204, v205
    v_cvt_pk_bf16_f32 v47, v206, v207
    v_cndmask_b32 v46, 0, v46, vcc
    v_cndmask_b32 v47, 0, v47, vcc
    buffer_store_dwordx4 v[44:47], v3, s[36:39], s14 offen offset:1024 sc1
    s_branch L_x0_done
L_k0:
    ds_read_b128 v[40:43], v243 offset:0
    ds_read_b128 v[44:47], v243 offset:1024
    ds_read_b128 v[48:51], v243 offset:2048
    ds_read_b128 v[52:55], v243 offset:3072
    ds_read_b128 v[136:139], v243 offset:4096
    ds_read_b128 v[140:143], v243 offset:5120
    ds_read_b128 v[160:163], v243 offset:6144
    ds_read_b128 v[164:167], v243 offset:7168
    s_waitcnt lgkmcnt(4)
    v_pk_add_f32 v[176:177], v[176:177], v[40:41]
    v_pk_add_f32 v[178:179], v[178:179], v[42:43]
    v_pk_add_f32 v[180:181], v[180:181], v[44:45]
    v_pk_add_f32 v[182:183], v[182:183], v[46:47]
    v_pk_add_f32 v[184:185], v[184:185], v[48:49]
    v_pk_add_f32 v[186:187], v[186:187], v[50:51]
    v_pk_add_f32 v[188:189], v[188:189], v[52:53]
    v_pk_add_f32 v[190:191], v[190:191], v[54:55]
    ds_read_b128 v[40:43], v243 offset:8192
    ds_read_b128 v[44:47], v243 offset:9216
    ds_read_b128 v[48:51], v243 offset:10240
    ds_read_b128 v[52:55], v243 offset:11264
    s_waitcnt lgkmcnt(4)
    v_pk_add_f32 v[176:177], v[176:177], v[136:137]
    v_pk_add_f32 v[178:179], v[178:179], v[138:139]
    v_pk_add_f32 v[180:181], v[180:181], v[140:141]
    v_pk_add_f32 v[182:183], v[182:183], v[142:143]
    v_pk_add_f32 v[184:185], v[184:185], v[160:161]
    v_pk_add_f32 v[186:187], v[186:187], v[162:163]
    v_pk_add_f32 v[188:189], v[188:189], v[164:165]
    v_pk_add_f32 v[190:191], v[190:191], v[166:167]
    s_waitcnt lgkmcnt(0)
    v_pk_add_f32 v[176:177], v[176:177], v[40:41]
    v_pk_add_f32 v[178:179], v[178:179], v[42:43]
    v_pk_add_f32 v[180:181], v[180:181], v[44:45]
    v_pk_add_f32 v[182:183], v[182:183], v[46:47]
    v_pk_add_f32 v[184:185], v[184:185], v[48:49]
    v_pk_add_f32 v[186:187], v[186:187], v[50:51]
    v_pk_add_f32 v[188:189], v[188:189], v[52:53]
    v_pk_add_f32 v[190:191], v[190:191], v[54:55]
    v_mov_b32 v56, v188
    v_mov_b32 v57, v188
    s_mov_b32 s54, 0x2f800000
    s_mov_b32 s62, 0x57800000
    v_permlane32_swap_b32 v56, v57
    v_pk_mul_f32 v[60:61], v[176:177], 0 op_sel_hi:[1,0]
    v_pk_mul_f32 v[62:63], v[178:179], 0 op_sel_hi:[1,0]
    v_rcp_f32 v58, v57
    v_pk_fma_f32 v[60:61], v[180:181], 0, v[60:61] op_sel_hi:[1,0,1]
    v_pk_fma_f32 v[62:63], v[182:183], 0, v[62:63] op_sel_hi:[1,0,1]
    v_pk_fma_f32 v[60:61], v[184:185], 0, v[60:61] op_sel_hi:[1,0,1]
    v_pk_fma_f32 v[62:63], v[186:187], 0, v[62:63] op_sel_hi:[1,0,1]
    v_pk_fma_f32 v[60:61], v[188:189], 0, v[60:61] op_sel_hi:[1,0,1]
    v_pk_fma_f32 v[62:63], v[190:191], 0, v[62:63] op_sel_hi:[1,0,1]
    v_pk_add_f32 v[60:61], v[60:61], v[62:63]
    v_add_f32 v60, v60, v61
    v_add_f32 v60, v60, v57
    v_cmp_ge_f32 vcc, v60, s54
    v_cmp_le_f32 s[56:57], v60, s62
    s_nop 1
    s_and_b64 s[56:57], s[56:57], vcc
    s_cmp_eq_u64 s[56:57], -1
    s_cselect_b32 s98, 0, 1
    s_cbranch_scc0 L_x0_done
    v_cmp_gt_u32 vcc, 32, v2
    v_pk_mul_f32 v[176:177], v[176:177], v[58:59] op_sel_hi:[1,0]
    v_pk_mul_f32 v[178:179], v[178:179], v[58:59] op_sel_hi:[1,0]
    v_pk_mul_f32 v[180:181], v[180:181], v[58:59] op_sel_hi:[1,0]
    v_pk_mul_f32 v[182:183], v[182:183], v[58:59] op_sel_hi:[1,0]
    v_pk_mul_f32 v[184:185], v[184:185], v[58:59] op_sel_hi:[1,0]
    v_pk_mul_f32 v[186:187], v[186:187], v[58:59] op_sel_hi:[1,0]
    v_pk_mul_f32 v[188:189], v[188:189], v[58:59] op_sel_hi:[1,0]
    v_pk_mul_f32 v[190:191], v[190:191], v[58:59] op_sel_hi:[1,0]
    v_cvt_pk_bf16_f32 v40, v176, v177
    v_cvt_pk_bf16_f32 v41, v178, v179
    v_cvt_pk_bf16_f32 v42, v180, v181
    v_cvt_pk_bf16_f32 v43, v182, v183
    buffer_store_dwordx4 v[40:43], v3, s[36:39], s14 offen sc1
    v_cvt_pk_bf16_f32 v44, v184, v185
    v_cvt_pk_bf16_f32 v45, v186, v187
    v_cvt_pk_bf16_f32 v46, v188, v189
    v_cvt_pk_bf16_f32 v47, v190, v191
    v_cndmask_b32 v46, 0, v46, vcc
    v_cndmask_b32 v47, 0, v47, vcc
    buffer_store_dwordx4 v[44:47], v3, s[36:39], s14 offen offset:1024 sc1
L_x0_done:
    s_setprio 2
    v_mfma_f32_32x32x16_bf16 v[96:111], v[144:147], v[32:35], 0
    v_exp_f32 v80, v80
    v_exp_f32 v81, v81
    v_exp_f32 v82, v82
    v_exp_f32 v83, v83
    v_mfma_f32_32x32x16_bf16 v[96:111], v[148:151], v[36:39], v[96:111]
    v_exp_f32 v84, v84
    v_exp_f32 v85, v85
    v_exp_f32 v86, v86
    v_exp_f32 v87, v87
    v_smfmac_f32_32x32x32_bf16 v[208:223], v[168:171], v[64:71], v4
    v_exp_f32 v88, v88
    v_exp_f32 v89, v89
    v_exp_f32 v90, v90
    v_exp_f32 v91, v91
    v_smfmac_f32_32x32x32_bf16 v[208:223], v[172:175], v[72:79], v4
    v_exp_f32 v92, v92
    v_exp_f32 v93, v93
    v_exp_f32 v94, v94
    v_exp_f32 v95, v95
    s_setprio 1
    v_mfma_f32_32x32x16_bf16 v[112:127], v[128:131], v[32:35], 0
    v_exp_f32 v96, v96
    v_exp_f32 v97, v97
    v_exp_f32 v98, v98
    v_exp_f32 v99, v99
    v_mfma_f32_32x32x16_bf16 v[112:127], v[132:135], v[36:39], v[112:127]
    v_exp_f32 v100, v100
    v_exp_f32 v101, v101
    v_exp_f32 v102, v102
    v_exp_f32 v103, v103
    v_smfmac_f32_32x32x32_bf16 v[208:223], v[152:155], v[80:87], v4
    v_exp_f32 v104, v104
    v_exp_f32 v105, v105
    v_exp_f32 v106, v106
    v_exp_f32 v107, v107
    v_smfmac_f32_32x32x32_bf16 v[208:223], v[156:159], v[88:95], v4
    v_exp_f32 v108, v108
    v_exp_f32 v109, v109
    v_exp_f32 v110, v110
    v_exp_f32 v111, v111
    s_setprio 0
    v_exp_f32 v112, v112
    v_exp_f32 v113, v113
    v_exp_f32 v114, v114
    v_exp_f32 v115, v115
    v_exp_f32 v116, v116
    v_exp_f32 v117, v117
    v_exp_f32 v118, v118
    v_exp_f32 v119, v119
    s_cmp_eq_u32 s100, 2
    s_cbranch_scc1 L_ns2
    s_sub_u32 s53, s8, 4096
    s_cmp_lt_u32 s100, 2
    s_cselect_b32 s53, s8, s53
    v_add_u32 v242, s53, v243
    ds_write_b128 v242, v[208:211] offset:49152
    ds_write_b128 v242, v[212:215] offset:50176
    ds_write_b128 v242, v[216:219] offset:51200
    ds_write_b128 v242, v[220:223] offset:52224
L_ns2:
    v_smfmac_f32_32x32x32_bf16 v[224:239], v[168:171], v[96:103], v4
    v_exp_f32 v120, v120
    v_exp_f32 v121, v121
    v_exp_f32 v122, v122
    v_exp_f32 v123, v123
    v_smfmac_f32_32x32x32_bf16 v[224:239], v[172:175], v[104:111], v4
    v_exp_f32 v124, v124
    v_exp_f32 v125, v125
    v_exp_f32 v126, v126
    v_exp_f32 v127, v127
    s_mov_b64 exec, 0xff
    buffer_load_dwordx2 v[250:251], v240, s[36:39], s16 offen sc1
    s_mov_b64 exec, -1
    v_smfmac_f32_32x32x32_bf16 v[224:239], v[152:155], v[112:119], v4
    v_smfmac_f32_32x32x32_bf16 v[224:239], v[156:159], v[120:127], v4
    s_nop 5
    s_cmp_eq_u32 s100, 3
    s_cbranch_scc1 L_ns3
    s_sub_u32 s53, s8, 4096
    s_cmp_lt_u32 s100, 3
    s_cselect_b32 s53, s8, s53
    v_add_u32 v242, s53, v243
    ds_write_b128 v242, v[224:227] offset:61440
    ds_write_b128 v242, v[228:231] offset:62464
    ds_write_b128 v242, v[232:235] offset:63488
    ds_write_b128 v242, v[236:239] offset:64512
L_ns3:
    s_waitcnt lgkmcnt(0)
    s_barrier
    s_cmp_eq_u32 s100, 2
    s_cbranch_scc1 L_k2
    s_cmp_eq_u32 s100, 3
    s_cbranch_scc0 L_x1_done
    ds_read_b128 v[40:43], v243 offset:61440
    ds_read_b128 v[44:47], v243 offset:62464
    ds_read_b128 v[48:51], v243 offset:63488
    ds_read_b128 v[52:55], v243 offset:64512
    v_add_u32 v243, 8192, v243
    ds_read_b128 v[176:179], v243 offset:57344
    ds_read_b128 v[180:183], v243 offset:58368
    ds_read_b128 v[184:187], v243 offset:59392
    ds_read_b128 v[188:191], v243 offset:60416
    ds_read_b128 v[192:195], v243 offset:61440
    ds_read_b128 v[196:199], v243 offset:62464
    ds_read_b128 v[200:203], v243 offset:63488
    ds_read_b128 v[204:207], v243 offset:64512
    s_waitcnt lgkmcnt(8)
    v_pk_add_f32 v[224:225], v[224:225], v[40:41]
    v_pk_add_f32 v[226:227], v[226:227], v[42:43]
    v_pk_add_f32 v[228:229], v[228:229], v[44:45]
    v_pk_add_f32 v[230:231], v[230:231], v[46:47]
    v_pk_add_f32 v[232:233], v[232:233], v[48:49]
    v_pk_add_f32 v[234:235], v[234:235], v[50:51]
    v_pk_add_f32 v[236:237], v[236:237], v[52:53]
    v_pk_add_f32 v[238:239], v[238:239], v[54:55]
    s_waitcnt lgkmcnt(4)
    v_pk_add_f32 v[224:225], v[224:225], v[176:177]
    v_pk_add_f32 v[226:227], v[226:227], v[178:179]
    v_pk_add_f32 v[228:229], v[228:229], v[180:181]
    v_pk_add_f32 v[230:231], v[230:231], v[182:183]
    v_pk_add_f32 v[232:233], v[232:233], v[184:185]
    v_pk_add_f32 v[234:235], v[234:235], v[186:187]
    v_pk_add_f32 v[236:237], v[236:237], v[188:189]
    v_pk_add_f32 v[238:239], v[238:239], v[190:191]
    s_waitcnt lgkmcnt(0)
    v_pk_add_f32 v[224:225], v[224:225], v[192:193]
    v_pk_add_f32 v[226:227], v[226:227], v[194:195]
    v_pk_add_f32 v[228:229], v[228:229], v[196:197]
    v_pk_add_f32 v[230:231], v[230:231], v[198:199]
    v_pk_add_f32 v[232:233], v[232:233], v[200:201]
    v_pk_add_f32 v[234:235], v[234:235], v[202:203]
    v_pk_add_f32 v[236:237], v[236:237], v[204:205]
    v_pk_add_f32 v[238:239], v[238:239], v[206:207]
    v_mov_b32 v56, v236
    v_mov_b32 v57, v236
    s_mov_b32 s54, 0x2f800000
    s_mov_b32 s62, 0x57800000
    v_permlane32_swap_b32 v56, v57
    v_pk_mul_f32 v[60:61], v[224:225], 0 op_sel_hi:[1,0]
    v_pk_mul_f32 v[62:63], v[226:227], 0 op_sel_hi:[1,0]
    v_rcp_f32 v58, v57
    v_pk_fma_f32 v[60:61], v[228:229], 0, v[60:61] op_sel_hi:[1,0,1]
    v_pk_fma_f32 v[62:63], v[230:231], 0, v[62:63] op_sel_hi:[1,0,1]
    v_pk_fma_f32 v[60:61], v[232:233], 0, v[60:61] op_sel_hi:[1,0,1]
    v_pk_fma_f32 v[62:63], v[234:235], 0, v[62:63] op_sel_hi:[1,0,1]
    v_pk_fma_f32 v[60:61], v[236:237], 0, v[60:61] op_sel_hi:[1,0,1]
    v_pk_fma_f32 v[62:63], v[238:239], 0, v[62:63] op_sel_hi:[1,0,1]
    v_pk_add_f32 v[60:61], v[60:61], v[62:63]
    v_add_f32 v60, v60, v61
    v_add_f32 v60, v60, v57
    v_cmp_ge_f32 vcc, v60, s54
    v_cmp_le_f32 s[56:57], v60, s62
    s_nop 1
    s_and_b64 s[56:57], s[56:57], vcc
    s_cmp_eq_u64 s[56:57], -1
    s_cselect_b32 s98, 0, 1
    s_cbranch_scc0 L_x1_done
    v_cmp_gt_u32 vcc, 32, v2
    v_pk_mul_f32 v[224:225], v[224:225], v[58:59] op_sel_hi:[1,0]
    v_pk_mul_f32 v[226:227], v[226:227], v[58:59] op_sel_hi:[1,0]
    v_pk_mul_f32 v[228:229], v[228:229], v[58:59] op_sel_hi:[1,0]
    v_pk_mul_f32 v[230:231], v[230:231], v[58:59] op_sel_hi:[1,0]
    v_pk_mul_f32 v[232:233], v[232:233], v[58:59] op_sel_hi:[1,0]
    v_pk_mul_f32 v[234:235], v[234:235], v[58:59] op_sel_hi:[1,0]
    v_pk_mul_f32 v[236:237], v[236:237], v[58:59] op_sel_hi:[1,0]
    v_pk_mul_f32 v[238:239], v[238:239], v[58:59] op_sel_hi:[1,0]
    v_cvt_pk_bf16_f32 v40, v224, v225
    v_cvt_pk_bf16_f32 v41, v226, v227
    v_cvt_pk_bf16_f32 v42, v228, v229
    v_cvt_pk_bf16_f32 v43, v230, v231
    buffer_store_dwordx4 v[40:43], v3, s[36:39], s14 offen sc1
    v_cvt_pk_bf16_f32 v44, v232, v233
    v_cvt_pk_bf16_f32 v45, v234, v235
    v_cvt_pk_bf16_f32 v46, v236, v237
    v_cvt_pk_bf16_f32 v47, v238, v239
    v_cndmask_b32 v46, 0, v46, vcc
    v_cndmask_b32 v47, 0, v47, vcc
    buffer_store_dwordx4 v[44:47], v3, s[36:39], s14 offen offset:1024 sc1
    s_branch L_x1_done
L_k2:
    ds_read_b128 v[40:43], v243 offset:49152
    ds_read_b128 v[44:47], v243 offset:50176
    ds_read_b128 v[48:51], v243 offset:51200
    ds_read_b128 v[52:55], v243 offset:52224
    ds_read_b128 v[176:179], v243 offset:53248
    ds_read_b128 v[180:183], v243 offset:54272
    ds_read_b128 v[184:187], v243 offset:55296
    ds_read_b128 v[188:191], v243 offset:56320
    ds_read_b128 v[192:195], v243 offset:57344
    ds_read_b128 v[196:199], v243 offset:58368
    ds_read_b128 v[200:203], v243 offset:59392
    ds_read_b128 v[204:207], v243 offset:60416
    s_waitcnt lgkmcnt(8)
    v_pk_add_f32 v[208:209], v[208:209], v[40:41]
    v_pk_add_f32 v[210:211], v[210:211], v[42:43]
    v_pk_add_f32 v[212:213], v[212:213], v[44:45]
    v_pk_add_f32 v[214:215], v[214:215], v[46:47]
    v_pk_add_f32 v[216:217], v[216:217], v[48:49]
    v_pk_add_f32 v[218:219], v[218:219], v[50:51]
    v_pk_add_f32 v[220:221], v[220:221], v[52:53]
    v_pk_add_f32 v[222:223], v[222:223], v[54:55]
    s_waitcnt lgkmcnt(4)
    v_pk_add_f32 v[208:209], v[208:209], v[176:177]
    v_pk_add_f32 v[210:211], v[210:211], v[178:179]
    v_pk_add_f32 v[212:213], v[212:213], v[180:181]
    v_pk_add_f32 v[214:215], v[214:215], v[182:183]
    v_pk_add_f32 v[216:217], v[216:217], v[184:185]
    v_pk_add_f32 v[218:219], v[218:219], v[186:187]
    v_pk_add_f32 v[220:221], v[220:221], v[188:189]
    v_pk_add_f32 v[222:223], v[222:223], v[190:191]
    s_waitcnt lgkmcnt(0)
    v_pk_add_f32 v[208:209], v[208:209], v[192:193]
    v_pk_add_f32 v[210:211], v[210:211], v[194:195]
    v_pk_add_f32 v[212:213], v[212:213], v[196:197]
    v_pk_add_f32 v[214:215], v[214:215], v[198:199]
    v_pk_add_f32 v[216:217], v[216:217], v[200:201]
    v_pk_add_f32 v[218:219], v[218:219], v[202:203]
    v_pk_add_f32 v[220:221], v[220:221], v[204:205]
    v_pk_add_f32 v[222:223], v[222:223], v[206:207]
    v_mov_b32 v56, v220
    v_mov_b32 v57, v220
    s_mov_b32 s54, 0x2f800000
    s_mov_b32 s62, 0x57800000
    v_permlane32_swap_b32 v56, v57
    v_pk_mul_f32 v[60:61], v[208:209], 0 op_sel_hi:[1,0]
    v_pk_mul_f32 v[62:63], v[210:211], 0 op_sel_hi:[1,0]
    v_rcp_f32 v58, v57
    v_pk_fma_f32 v[60:61], v[212:213], 0, v[60:61] op_sel_hi:[1,0,1]
    v_pk_fma_f32 v[62:63], v[214:215], 0, v[62:63] op_sel_hi:[1,0,1]
    v_pk_fma_f32 v[60:61], v[216:217], 0, v[60:61] op_sel_hi:[1,0,1]
    v_pk_fma_f32 v[62:63], v[218:219], 0, v[62:63] op_sel_hi:[1,0,1]
    v_pk_fma_f32 v[60:61], v[220:221], 0, v[60:61] op_sel_hi:[1,0,1]
    v_pk_fma_f32 v[62:63], v[222:223], 0, v[62:63] op_sel_hi:[1,0,1]
    v_pk_add_f32 v[60:61], v[60:61], v[62:63]
    v_add_f32 v60, v60, v61
    v_add_f32 v60, v60, v57
    v_cmp_ge_f32 vcc, v60, s54
    v_cmp_le_f32 s[56:57], v60, s62
    s_nop 1
    s_and_b64 s[56:57], s[56:57], vcc
    s_cmp_eq_u64 s[56:57], -1
    s_cselect_b32 s98, 0, 1
    s_cbranch_scc0 L_x1_done
    v_cmp_gt_u32 vcc, 32, v2
    v_pk_mul_f32 v[208:209], v[208:209], v[58:59] op_sel_hi:[1,0]
    v_pk_mul_f32 v[210:211], v[210:211], v[58:59] op_sel_hi:[1,0]
    v_pk_mul_f32 v[212:213], v[212:213], v[58:59] op_sel_hi:[1,0]
    v_pk_mul_f32 v[214:215], v[214:215], v[58:59] op_sel_hi:[1,0]
    v_pk_mul_f32 v[216:217], v[216:217], v[58:59] op_sel_hi:[1,0]
    v_pk_mul_f32 v[218:219], v[218:219], v[58:59] op_sel_hi:[1,0]
    v_pk_mul_f32 v[220:221], v[220:221], v[58:59] op_sel_hi:[1,0]
    v_pk_mul_f32 v[222:223], v[222:223], v[58:59] op_sel_hi:[1,0]
    v_cvt_pk_bf16_f32 v40, v208, v209
    v_cvt_pk_bf16_f32 v41, v210, v211
    v_cvt_pk_bf16_f32 v42, v212, v213
    v_cvt_pk_bf16_f32 v43, v214, v215
    buffer_store_dwordx4 v[40:43], v3, s[36:39], s14 offen sc1
    v_cvt_pk_bf16_f32 v44, v216, v217
    v_cvt_pk_bf16_f32 v45, v218, v219
    v_cvt_pk_bf16_f32 v46, v220, v221
    v_cvt_pk_bf16_f32 v47, v222, v223
    v_cndmask_b32 v46, 0, v46, vcc
    v_cndmask_b32 v47, 0, v47, vcc
    buffer_store_dwordx4 v[44:47], v3, s[36:39], s14 offen offset:1024 sc1
L_x1_done:
    s_setprio 0
    s_cmp_lg_u32 s98, 0
    s_cbranch_scc1 L_fallback
L_p3:
    s_add_u32 s62, s3, 0
    s_and_b32 s62, s62, 7
    s_lshl_b32 s54, s62, 11
    s_add_u32 s54, s54, s17
    s_add_u32 s62, s3, 1
    s_and_b32 s62, s62, 7
    s_lshl_b32 s55, s62, 11
    s_add_u32 s55, s55, s17
    s_add_u32 s62, s3, 2
    s_and_b32 s62, s62, 7
    s_lshl_b32 s56, s62, 11
    s_add_u32 s56, s56, s17
    s_add_u32 s62, s3, 3
    s_and_b32 s62, s62, 7
    s_lshl_b32 s57, s62, 11
    s_add_u32 s57, s57, s17
    s_add_u32 s62, s3, 4
    s_and_b32 s62, s62, 7
    s_lshl_b32 s58, s62, 11
    s_add_u32 s58, s58, s17
    s_add_u32 s62, s3, 5
    s_and_b32 s62, s62, 7
    s_lshl_b32 s59, s62, 11
    s_add_u32 s59, s59, s17
    s_add_u32 s62, s3, 6
    s_and_b32 s62, s62, 7
    s_lshl_b32 s60, s62, 11
    s_add_u32 s60, s60, s17
    s_add_u32 s62, s3, 7
    s_and_b32 s62, s62, 7
    s_lshl_b32 s61, s62, 11
    s_add_u32 s61, s61, s17
    s_cmp_ge_u32 s23, 28
    s_cbranch_scc1 L_fin
    s_cmp_lg_u32 s49, 0
    s_cbranch_scc1 L_p3b
    s_waitcnt vmcnt(0)
    v_cmp_eq_u64 vcc, s[50:51], v[250:251]
    s_nop 1
    s_and_b32 s63, vcc_lo, 0xff
    s_cmp_eq_u32 s63, 0xff
    s_cbranch_scc1 L_opa_ok
    s_mov_b32 s62, 1000000
L_opa_chk:
    s_waitcnt vmcnt(0)
    v_cmp_eq_u64 vcc, s[50:51], v[250:251]
    s_nop 1
    s_and_b32 s63, vcc_lo, 0xff
    s_cmp_eq_u32 s63, 0xff
    s_cbranch_scc1 L_opa_ok
    s_sub_u32 s62, s62, 1
    s_cbranch_scc1 L_opa_ok
    s_sleep 2
    s_mov_b64 exec, 0xff
    buffer_load_dwordx2 v[250:251], v240, s[36:39], s16 offen sc1
    s_mov_b64 exec, -1
    s_branch L_opa_chk
L_opa_ok:
    buffer_load_dwordx4 v[96:99], v3, s[36:39], s54 offen offset:0 sc1
    buffer_load_dwordx4 v[100:103], v3, s[36:39], s54 offen offset:1024 sc1
L_p3b:
    s_add_u32 s62, s3, 0
    s_and_b32 s62, s62, 7
    s_mul_i32 s62, s62, 3584
    v_add_u32 v14, s62, v244
    v_xor_b32 v15, 64, v14
    ds_read_b64_tr_b16 v[48:49], v14 offset:0
    ds_read_b64_tr_b16 v[50:51], v14 offset:1024
    ds_read_b64_tr_b16 v[52:53], v15 offset:0
    ds_read_b64_tr_b16 v[54:55], v15 offset:1024
    ds_read_b64_tr_b16 v[56:57], v14 offset:2048
    ds_read_b64_tr_b16 v[58:59], v14 offset:3072
    ds_read_b64_tr_b16 v[60:61], v15 offset:2048
    ds_read_b64_tr_b16 v[62:63], v15 offset:3072
    s_add_u32 s62, s3, 1
    s_and_b32 s62, s62, 7
    s_mul_i32 s62, s62, 3584
    v_add_u32 v14, s62, v244
    v_xor_b32 v15, 64, v14
    ds_read_b64_tr_b16 v[64:65], v14 offset:0
    ds_read_b64_tr_b16 v[66:67], v14 offset:1024
    ds_read_b64_tr_b16 v[68:69], v15 offset:0
    ds_read_b64_tr_b16 v[70:71], v15 offset:1024
    ds_read_b64_tr_b16 v[72:73], v14 offset:2048
    ds_read_b64_tr_b16 v[74:75], v14 offset:3072
    ds_read_b64_tr_b16 v[76:77], v15 offset:2048
    ds_read_b64_tr_b16 v[78:79], v15 offset:3072
    s_add_u32 s62, s3, 2
    s_and_b32 s62, s62, 7
    s_mul_i32 s62, s62, 3584
    v_add_u32 v14, s62, v244
    v_xor_b32 v15, 64, v14
    ds_read_b64_tr_b16 v[80:81], v14 offset:0
    ds_read_b64_tr_b16 v[82:83], v14 offset:1024
    ds_read_b64_tr_b16 v[84:85], v15 offset:0
    ds_read_b64_tr_b16 v[86:87], v15 offset:1024
    ds_read_b64_tr_b16 v[88:89], v14 offset:2048
    ds_read_b64_tr_b16 v[90:91], v14 offset:3072
    ds_read_b64_tr_b16 v[92:93], v15 offset:2048
    ds_read_b64_tr_b16 v[94:95], v15 offset:3072
    s_add_u32 s62, s3, 3
    s_and_b32 s62, s62, 7
    s_mul_i32 s62, s62, 3584
    v_add_u32 v14, s62, v244
    v_xor_b32 v15, 64, v14
    ds_read_b64_tr_b16 v[160:161], v14 offset:0
    ds_read_b64_tr_b16 v[162:163], v14 offset:1024
    ds_read_b64_tr_b16 v[164:165], v15 offset:0
    ds_read_b64_tr_b16 v[166:167], v15 offset:1024
    ds_read_b64_tr_b16 v[168:169], v14 offset:2048
    ds_read_b64_tr_b16 v[170:171], v14 offset:3072
    ds_read_b64_tr_b16 v[172:173], v15 offset:2048
    ds_read_b64_tr_b16 v[174:175], v15 offset:3072
    s_add_u32 s62, s3, 4
    s_and_b32 s62, s62, 7
    s_mul_i32 s62, s62, 3584
    v_add_u32 v14, s62, v244
    v_xor_b32 v15, 64, v14
    ds_read_b64_tr_b16 v[176:177], v14 offset:0
    ds_read_b64_tr_b16 v[178:179], v14 offset:1024
    ds_read_b64_tr_b16 v[180:181], v15 offset:0
    ds_read_b64_tr_b16 v[182:183], v15 offset:1024
    ds_read_b64_tr_b16 v[184:185], v14 offset:2048
    ds_read_b64_tr_b16 v[186:187], v14 offset:3072
    ds_read_b64_tr_b16 v[188:189], v15 offset:2048
    ds_read_b64_tr_b16 v[190:191], v15 offset:3072
    s_add_u32 s62, s3, 5
    s_and_b32 s62, s62, 7
    s_mul_i32 s62, s62, 3584
    v_add_u32 v14, s62, v244
    v_xor_b32 v15, 64, v14
    ds_read_b64_tr_b16 v[192:193], v14 offset:0
    ds_read_b64_tr_b16 v[194:195], v14 offset:1024
    ds_read_b64_tr_b16 v[196:197], v15 offset:0
    ds_read_b64_tr_b16 v[198:199], v15 offset:1024
    ds_read_b64_tr_b16 v[200:201], v14 offset:2048
    ds_read_b64_tr_b16 v[202:203], v14 offset:3072
    ds_read_b64_tr_b16 v[204:205], v15 offset:2048
    ds_read_b64_tr_b16 v[206:207], v15 offset:3072
    s_add_u32 s62, s3, 6
    s_and_b32 s62, s62, 7
    s_mul_i32 s62, s62, 3584
    v_add_u32 v14, s62, v244
    v_xor_b32 v15, 64, v14
    ds_read_b64_tr_b16 v[208:209], v14 offset:0
    ds_read_b64_tr_b16 v[210:211], v14 offset:1024
    ds_read_b64_tr_b16 v[212:213], v15 offset:0
    ds_read_b64_tr_b16 v[214:215], v15 offset:1024
    ds_read_b64_tr_b16 v[216:217], v14 offset:2048
    ds_read_b64_tr_b16 v[218:219], v14 offset:3072
    ds_read_b64_tr_b16 v[220:221], v15 offset:2048
    ds_read_b64_tr_b16 v[222:223], v15 offset:3072
    s_add_u32 s62, s3, 7
    s_and_b32 s62, s62, 7
    s_mul_i32 s62, s62, 3584
    v_add_u32 v14, s62, v244
    v_xor_b32 v15, 64, v14
    ds_read_b64_tr_b16 v[224:225], v14 offset:0
    ds_read_b64_tr_b16 v[226:227], v14 offset:1024
    ds_read_b64_tr_b16 v[228:229], v15 offset:0
    ds_read_b64_tr_b16 v[230:231], v15 offset:1024
    ds_read_b64_tr_b16 v[232:233], v14 offset:2048
    ds_read_b64_tr_b16 v[234:235], v14 offset:3072
    ds_read_b64_tr_b16 v[236:237], v15 offset:2048
    ds_read_b64_tr_b16 v[238:239], v15 offset:3072
    s_cmp_eq_u32 s49, 0
    s_cbranch_scc1 L_p3c
    s_waitcnt vmcnt(0)
    v_cmp_eq_u64 vcc, s[50:51], v[250:251]
    s_nop 1
    s_and_b32 s63, vcc_lo, 0xff
    s_cmp_eq_u32 s63, 0xff
    s_cbranch_scc1 L_opb_ok
    s_mov_b32 s62, 1000000
L_opb_chk:
    s_waitcnt vmcnt(0)
    v_cmp_eq_u64 vcc, s[50:51], v[250:251]
    s_nop 1
    s_and_b32 s63, vcc_lo, 0xff
    s_cmp_eq_u32 s63, 0xff
    s_cbranch_scc1 L_opb_ok
    s_sub_u32 s62, s62, 1
    s_cbranch_scc1 L_opb_ok
    s_sleep 2
    s_mov_b64 exec, 0xff
    buffer_load_dwordx2 v[250:251], v240, s[36:39], s16 offen sc1
    s_mov_b64 exec, -1
    s_branch L_opb_chk
L_opb_ok:
    buffer_load_dwordx4 v[96:99], v3, s[36:39], s54 offen offset:0 sc1
    buffer_load_dwordx4 v[100:103], v3, s[36:39], s54 offen offset:1024 sc1
L_p3c:
    buffer_load_dwordx4 v[104:107], v3, s[36:39], s55 offen offset:0 sc1
    buffer_load_dwordx4 v[108:111], v3, s[36:39], s55 offen offset:1024 sc1
    buffer_load_dwordx4 v[112:115], v3, s[36:39], s56 offen offset:0 sc1
    buffer_load_dwordx4 v[116:119], v3, s[36:39], s56 offen offset:1024 sc1
    buffer_load_dwordx4 v[120:123], v3, s[36:39], s57 offen offset:0 sc1
    buffer_load_dwordx4 v[124:127], v3, s[36:39], s57 offen offset:1024 sc1
    buffer_load_dwordx4 v[128:131], v3, s[36:39], s58 offen offset:0 sc1
    buffer_load_dwordx4 v[132:135], v3, s[36:39], s58 offen offset:1024 sc1
    buffer_load_dwordx4 v[136:139], v3, s[36:39], s59 offen offset:0 sc1
    buffer_load_dwordx4 v[140:143], v3, s[36:39], s59 offen offset:1024 sc1
    buffer_load_dwordx4 v[144:147], v3, s[36:39], s60 offen offset:0 sc1
    buffer_load_dwordx4 v[148:151], v3, s[36:39], s60 offen offset:1024 sc1
    buffer_load_dwordx4 v[152:155], v3, s[36:39], s61 offen offset:0 sc1
    buffer_load_dwordx4 v[156:159], v3, s[36:39], s61 offen offset:1024 sc1
    v_mov_b32 v16, 0
    v_mov_b32 v17, 0
    v_mov_b32 v18, 0
    v_mov_b32 v19, 0
    v_mov_b32 v20, 0
    v_mov_b32 v21, 0
    v_mov_b32 v22, 0
    v_mov_b32 v23, 0
    v_mov_b32 v24, 0
    v_mov_b32 v25, 0
    v_mov_b32 v26, 0
    v_mov_b32 v27, 0
    v_mov_b32 v28, 0
    v_mov_b32 v29, 0
    v_mov_b32 v30, 0
    v_mov_b32 v31, 0
    v_mov_b32 v32, 0
    v_mov_b32 v33, 0
    v_mov_b32 v34, 0
    v_mov_b32 v35, 0
    v_mov_b32 v36, 0
    v_mov_b32 v37, 0
    v_mov_b32 v38, 0
    v_mov_b32 v39, 0
    v_mov_b32 v40, 0
    v_mov_b32 v41, 0
    v_mov_b32 v42, 0
    v_mov_b32 v43, 0
    v_mov_b32 v44, 0
    v_mov_b32 v45, 0
    v_mov_b32 v46, 0
    v_mov_b32 v47, 0
    v_xor_b32 v9, 32, v246
    v_xor_b32 v10, 64, v246
    v_xor_b32 v11, 96, v246
    v_xor_b32 v12, 16, v247
    s_mov_b32 s62, 1000000
    s_movk_i32 s63, 0xff
    s_mov_b64 s[98:99], -1
    s_waitcnt lgkmcnt(0)
L_pass:
    s_bitcmp0_b32 s63, 0
    s_cbranch_scc1 L_next0
    s_waitcnt vmcnt(14)
    v_max3_u32 v13, v96, v99, v100
    v_max_u32 v13, v13, v103
    v_cmp_eq_u32 vcc, -1, v13
    s_nop 1
    s_and_b64 vcc, vcc, s[98:99]
    s_cbranch_scc0 L_go0
    buffer_load_dwordx4 v[96:99], v3, s[36:39], s54 offen offset:0 sc1
    buffer_load_dwordx4 v[100:103], v3, s[36:39], s54 offen offset:1024 sc1
    s_branch L_next0
L_go0:
    s_bitset0_b32 s63, 0
    v_mfma_f32_32x32x16_bf16 v[16:31], v[48:51], v[96:99], v[16:31]
    v_mfma_f32_32x32x16_bf16 v[32:47], v[52:55], v[96:99], v[32:47]
    v_mfma_f32_32x32x16_bf16 v[16:31], v[56:59], v[100:103], v[16:31]
    v_mfma_f32_32x32x16_bf16 v[32:47], v[60:63], v[100:103], v[32:47]
L_next0:
    s_bitcmp0_b32 s63, 1
    s_cbranch_scc1 L_next1
    s_waitcnt vmcnt(12)
    v_max3_u32 v13, v104, v107, v108
    v_max_u32 v13, v13, v111
    v_cmp_eq_u32 vcc, -1, v13
    s_nop 1
    s_and_b64 vcc, vcc, s[98:99]
    s_cbranch_scc0 L_go1
    buffer_load_dwordx4 v[104:107], v3, s[36:39], s55 offen offset:0 sc1
    buffer_load_dwordx4 v[108:111], v3, s[36:39], s55 offen offset:1024 sc1
    s_branch L_next1
L_go1:
    s_and_b32 s53, s63, 1
    s_cbranch_scc1 L_next1
    s_bitset0_b32 s63, 1
    v_mfma_f32_32x32x16_bf16 v[16:31], v[64:67], v[104:107], v[16:31]
    v_mfma_f32_32x32x16_bf16 v[32:47], v[68:71], v[104:107], v[32:47]
    v_mfma_f32_32x32x16_bf16 v[16:31], v[72:75], v[108:111], v[16:31]
    v_mfma_f32_32x32x16_bf16 v[32:47], v[76:79], v[108:111], v[32:47]
L_next1:
    s_bitcmp0_b32 s63, 2
    s_cbranch_scc1 L_next2
    s_waitcnt vmcnt(10)
    v_max3_u32 v13, v112, v115, v116
    v_max_u32 v13, v13, v119
    v_cmp_eq_u32 vcc, -1, v13
    s_nop 1
    s_and_b64 vcc, vcc, s[98:99]
    s_cbranch_scc0 L_go2
    buffer_load_dwordx4 v[112:115], v3, s[36:39], s56 offen offset:0 sc1
    buffer_load_dwordx4 v[116:119], v3, s[36:39], s56 offen offset:1024 sc1
    s_branch L_next2
L_go2:
    s_and_b32 s53, s63, 3
    s_cbranch_scc1 L_next2
    s_bitset0_b32 s63, 2
    v_mfma_f32_32x32x16_bf16 v[16:31], v[80:83], v[112:115], v[16:31]
    v_mfma_f32_32x32x16_bf16 v[32:47], v[84:87], v[112:115], v[32:47]
    v_mfma_f32_32x32x16_bf16 v[16:31], v[88:91], v[116:119], v[16:31]
    v_mfma_f32_32x32x16_bf16 v[32:47], v[92:95], v[116:119], v[32:47]
L_next2:
    s_bitcmp0_b32 s63, 3
    s_cbranch_scc1 L_next3
    s_waitcnt vmcnt(8)
    v_max3_u32 v13, v120, v123, v124
    v_max_u32 v13, v13, v127
    v_cmp_eq_u32 vcc, -1, v13
    s_nop 1
    s_and_b64 vcc, vcc, s[98:99]
    s_cbranch_scc0 L_go3
    buffer_load_dwordx4 v[120:123], v3, s[36:39], s57 offen offset:0 sc1
    buffer_load_dwordx4 v[124:127], v3, s[36:39], s57 offen offset:1024 sc1
    s_branch L_next3
L_go3:
    s_and_b32 s53, s63, 7
    s_cbranch_scc1 L_next3
    s_bitset0_b32 s63, 3
    v_mfma_f32_32x32x16_bf16 v[16:31], v[160:163], v[120:123], v[16:31]
    v_mfma_f32_32x32x16_bf16 v[32:47], v[164:167], v[120:123], v[32:47]
    v_mfma_f32_32x32x16_bf16 v[16:31], v[168:171], v[124:127], v[16:31]
    v_mfma_f32_32x32x16_bf16 v[32:47], v[172:175], v[124:127], v[32:47]
L_next3:
    s_bitcmp0_b32 s63, 4
    s_cbranch_scc1 L_next4
    s_waitcnt vmcnt(6)
    v_max3_u32 v13, v128, v131, v132
    v_max_u32 v13, v13, v135
    v_cmp_eq_u32 vcc, -1, v13
    s_nop 1
    s_and_b64 vcc, vcc, s[98:99]
    s_cbranch_scc0 L_go4
    buffer_load_dwordx4 v[128:131], v3, s[36:39], s58 offen offset:0 sc1
    buffer_load_dwordx4 v[132:135], v3, s[36:39], s58 offen offset:1024 sc1
    s_branch L_next4
L_go4:
    s_and_b32 s53, s63, 15
    s_cbranch_scc1 L_next4
    s_bitset0_b32 s63, 4
    v_mfma_f32_32x32x16_bf16 v[16:31], v[176:179], v[128:131], v[16:31]
    v_mfma_f32_32x32x16_bf16 v[32:47], v[180:183], v[128:131], v[32:47]
    v_mfma_f32_32x32x16_bf16 v[16:31], v[184:187], v[132:135], v[16:31]
    v_mfma_f32_32x32x16_bf16 v[32:47], v[188:191], v[132:135], v[32:47]
L_next4:
    s_bitcmp0_b32 s63, 5
    s_cbranch_scc1 L_next5
    s_waitcnt vmcnt(4)
    v_max3_u32 v13, v136, v139, v140
    v_max_u32 v13, v13, v143
    v_cmp_eq_u32 vcc, -1, v13
    s_nop 1
    s_and_b64 vcc, vcc, s[98:99]
    s_cbranch_scc0 L_go5
    buffer_load_dwordx4 v[136:139], v3, s[36:39], s59 offen offset:0 sc1
    buffer_load_dwordx4 v[140:143], v3, s[36:39], s59 offen offset:1024 sc1
    s_branch L_next5
L_go5:
    s_and_b32 s53, s63, 31
    s_cbranch_scc1 L_next5
    s_bitset0_b32 s63, 5
    v_mfma_f32_32x32x16_bf16 v[16:31], v[192:195], v[136:139], v[16:31]
    v_mfma_f32_32x32x16_bf16 v[32:47], v[196:199], v[136:139], v[32:47]
    v_mfma_f32_32x32x16_bf16 v[16:31], v[200:203], v[140:143], v[16:31]
    v_mfma_f32_32x32x16_bf16 v[32:47], v[204:207], v[140:143], v[32:47]
L_next5:
    s_bitcmp0_b32 s63, 6
    s_cbranch_scc1 L_next6
    s_waitcnt vmcnt(2)
    v_max3_u32 v13, v144, v147, v148
    v_max_u32 v13, v13, v151
    v_cmp_eq_u32 vcc, -1, v13
    s_nop 1
    s_and_b64 vcc, vcc, s[98:99]
    s_cbranch_scc0 L_go6
    buffer_load_dwordx4 v[144:147], v3, s[36:39], s60 offen offset:0 sc1
    buffer_load_dwordx4 v[148:151], v3, s[36:39], s60 offen offset:1024 sc1
    s_branch L_next6
L_go6:
    s_and_b32 s53, s63, 63
    s_cbranch_scc1 L_next6
    s_bitset0_b32 s63, 6
    v_mfma_f32_32x32x16_bf16 v[16:31], v[208:211], v[144:147], v[16:31]
    v_mfma_f32_32x32x16_bf16 v[32:47], v[212:215], v[144:147], v[32:47]
    v_mfma_f32_32x32x16_bf16 v[16:31], v[216:219], v[148:151], v[16:31]
    v_mfma_f32_32x32x16_bf16 v[32:47], v[220:223], v[148:151], v[32:47]
L_next6:
    s_bitcmp0_b32 s63, 7
    s_cbranch_scc1 L_next7
    s_waitcnt vmcnt(0)
    v_max3_u32 v13, v152, v155, v156
    v_max_u32 v13, v13, v159
    v_cmp_eq_u32 vcc, -1, v13
    s_nop 1
    s_and_b64 vcc, vcc, s[98:99]
    s_cbranch_scc0 L_go7
    buffer_load_dwordx4 v[152:155], v3, s[36:39], s61 offen offset:0 sc1
    buffer_load_dwordx4 v[156:159], v3, s[36:39], s61 offen offset:1024 sc1
    s_branch L_next7
L_go7:
    s_and_b32 s53, s63, 127
    s_cbranch_scc1 L_next7
    s_bitset0_b32 s63, 7
    v_mfma_f32_32x32x16_bf16 v[16:31], v[224:227], v[152:155], v[16:31]
    v_mfma_f32_32x32x16_bf16 v[32:47], v[228:231], v[152:155], v[32:47]
    v_mfma_f32_32x32x16_bf16 v[16:31], v[232:235], v[156:159], v[16:31]
    v_mfma_f32_32x32x16_bf16 v[32:47], v[236:239], v[156:159], v[32:47]
L_next7:
    s_cmp_eq_u32 s63, 0
    s_cbranch_scc1 L_passed
    s_sub_u32 s62, s62, 1
    s_cselect_b64 s[98:99], 0, s[98:99]
    s_waitcnt vmcnt(0)
    s_branch L_pass
L_passed:
    s_mov_b32 s62, 14336
    s_nop 10
    ds_write_b128 v246, v[16:19] offset:0
    ds_write_b128 v9, v[20:23] offset:0
    ds_write_b128 v10, v[24:27] offset:0
    ds_write_b128 v11, v[28:31] offset:0
    ds_write_b128 v246, v[32:35] offset:128
    ds_write_b128 v9, v[36:39] offset:128
    ds_write_b128 v10, v[40:43] offset:128
    ds_write_b128 v11, v[44:47] offset:128
    s_waitcnt lgkmcnt(0)
    s_barrier
    ds_read_b128 v[64:67], v247 offset:0
    ds_read_b128 v[68:71], v12 offset:0
    ds_read_b128 v[72:75], v247 offset:24576
    ds_read_b128 v[76:79], v12 offset:24576
    ds_read_b128 v[80:83], v247 offset:2048
    ds_read_b128 v[84:87], v12 offset:2048
    ds_read_b128 v[88:91], v247 offset:26624
    ds_read_b128 v[92:95], v12 offset:26624
    s_waitcnt lgkmcnt(4)
    v_pk_add_f32 v[64:65], v[64:65], v[72:73]
    v_pk_add_f32 v[66:67], v[66:67], v[74:75]
    v_pk_add_f32 v[68:69], v[68:69], v[76:77]
    v_pk_add_f32 v[70:71], v[70:71], v[78:79]
    v_cvt_pk_bf16_f32 v96, v64, v65
    v_cvt_pk_bf16_f32 v97, v66, v67
    v_cvt_pk_bf16_f32 v98, v68, v69
    v_cvt_pk_bf16_f32 v99, v70, v71
    buffer_store_dwordx4 v[96:99], v245, s[44:47], 0 offen sc1
    s_waitcnt lgkmcnt(0)
    v_pk_add_f32 v[80:81], v[80:81], v[88:89]
    v_pk_add_f32 v[82:83], v[82:83], v[90:91]
    v_pk_add_f32 v[84:85], v[84:85], v[92:93]
    v_pk_add_f32 v[86:87], v[86:87], v[94:95]
    v_cvt_pk_bf16_f32 v100, v80, v81
    v_cvt_pk_bf16_f32 v101, v82, v83
    v_cvt_pk_bf16_f32 v102, v84, v85
    v_cvt_pk_bf16_f32 v103, v86, v87
    buffer_store_dwordx4 v[100:103], v245, s[44:47], s62 offen sc1
L_fin:
L_end:
    s_endpgm
L_fallback:
    s_cmp_lg_u32 s100, 0
    s_cbranch_scc1 L_fbq0
    v_mov_b32 v48, v8
    v_mov_b32 v49, v9
    v_mov_b32 v50, v10
    v_mov_b32 v51, v11
    v_mov_b32 v52, v12
    v_mov_b32 v53, v13
    v_mov_b32 v54, v14
    v_mov_b32 v55, v15
L_fbq0:
    s_cmp_lg_u32 s100, 1
    s_cbranch_scc1 L_fbq1
    v_mov_b32 v48, v16
    v_mov_b32 v49, v17
    v_mov_b32 v50, v18
    v_mov_b32 v51, v19
    v_mov_b32 v52, v20
    v_mov_b32 v53, v21
    v_mov_b32 v54, v22
    v_mov_b32 v55, v23
L_fbq1:
    s_cmp_lg_u32 s100, 2
    s_cbranch_scc1 L_fbq2
    v_mov_b32 v48, v24
    v_mov_b32 v49, v25
    v_mov_b32 v50, v26
    v_mov_b32 v51, v27
    v_mov_b32 v52, v28
    v_mov_b32 v53, v29
    v_mov_b32 v54, v30
    v_mov_b32 v55, v31
L_fbq2:
    s_cmp_lg_u32 s100, 3
    s_cbranch_scc1 L_fbq3
    v_mov_b32 v48, v32
    v_mov_b32 v49, v33
    v_mov_b32 v50, v34
    v_mov_b32 v51, v35
    v_mov_b32 v52, v36
    v_mov_b32 v53, v37
    v_mov_b32 v54, v38
    v_mov_b32 v55, v39
L_fbq3:
    s_lshl_b32 s58, s52, 18
    s_mov_b32 s59, 64
    v_mov_b32 v99, 0xff800000
L_fb1:
    buffer_load_dwordx4 v[128:131], v3, s[36:39], s58 offen sc1
    buffer_load_dwordx4 v[132:135], v3, s[36:39], s58 offen offset:1024 sc1
    s_waitcnt vmcnt(0)
    v_mfma_f32_32x32x16_bf16 v[80:95], v[128:131], v[48:51], 0
    v_mfma_f32_32x32x16_bf16 v[80:95], v[132:135], v[52:55], v[80:95]
    s_add_u32 s58, s58, 4096
    s_sub_u32 s59, s59, 1
    s_nop 15
    v_max3_f32 v99, v99, v80, v81
    v_max3_f32 v99, v99, v82, v83
    v_max3_f32 v99, v99, v84, v85
    v_max3_f32 v99, v99, v86, v87
    v_max3_f32 v99, v99, v88, v89
    v_max3_f32 v99, v99, v90, v91
    v_max3_f32 v99, v99, v92, v93
    v_max3_f32 v99, v99, v94, v95
    s_cmp_lg_u32 s59, 0
    s_cbranch_scc1 L_fb1
    v_mov_b32 v100, v99
    s_nop 1
    v_permlane32_swap_b32 v99, v100
    s_nop 1
    v_max_f32 v99, v99, v100
    v_sub_f32 v99, 0, v99
    v_and_b32 v100, 0xffff0000, v99
    v_sub_f32 v101, v99, v100
    v_and_b32 v102, 0xffff0000, v101
    v_sub_f32 v101, v101, v102
    v_lshrrev_b32 v100, 16, v100
    v_or_b32 v100, v100, v102
    v_lshrrev_b32 v101, 16, v101
    v_cmp_gt_u32 vcc, 32, v2
    s_lshl_b32 s58, s52, 18
    s_mov_b32 s59, 64
    v_cndmask_b32 v54, v100, v54, vcc
    v_cndmask_b32 v55, v101, v55, vcc
    v_mov_b32 v64, 0
    v_mov_b32 v65, 0
    v_mov_b32 v66, 0
    v_mov_b32 v67, 0
    v_mov_b32 v68, 0
    v_mov_b32 v69, 0
    v_mov_b32 v70, 0
    v_mov_b32 v71, 0
    v_mov_b32 v72, 0
    v_mov_b32 v73, 0
    v_mov_b32 v74, 0
    v_mov_b32 v75, 0
    v_mov_b32 v76, 0
    v_mov_b32 v77, 0
    v_mov_b32 v78, 0
    v_mov_b32 v79, 0
L_fb2:
    buffer_load_dwordx4 v[128:131], v3, s[36:39], s58 offen sc1
    buffer_load_dwordx4 v[132:135], v3, s[36:39], s58 offen offset:1024 sc1
    buffer_load_dwordx4 v[136:139], v3, s[36:39], s58 offen offset:2048 sc1
    buffer_load_dwordx4 v[140:143], v3, s[36:39], s58 offen offset:3072 sc1
    s_waitcnt vmcnt(0)
    v_mfma_f32_32x32x16_bf16 v[80:95], v[128:131], v[48:51], 0
    v_mfma_f32_32x32x16_bf16 v[80:95], v[132:135], v[52:55], v[80:95]
    s_add_u32 s58, s58, 4096
    s_sub_u32 s59, s59, 1
    s_nop 15
    v_exp_f32 v80, v80
    v_exp_f32 v81, v81
    v_exp_f32 v82, v82
    v_exp_f32 v83, v83
    v_exp_f32 v84, v84
    v_exp_f32 v85, v85
    v_exp_f32 v86, v86
    v_exp_f32 v87, v87
    v_exp_f32 v88, v88
    v_exp_f32 v89, v89
    v_exp_f32 v90, v90
    v_exp_f32 v91, v91
    v_exp_f32 v92, v92
    v_exp_f32 v93, v93
    v_exp_f32 v94, v94
    v_exp_f32 v95, v95
    s_nop 1
    v_smfmac_f32_32x32x32_bf16 v[64:79], v[136:139], v[80:87], v4
    v_smfmac_f32_32x32x32_bf16 v[64:79], v[140:143], v[88:95], v4
    s_cmp_lg_u32 s59, 0
    s_cbranch_scc1 L_fb2
    s_nop 15
    v_mov_b32 v96, v76
    v_mov_b32 v97, v76
    s_nop 1
    v_permlane32_swap_b32 v96, v97
    s_nop 1
    v_rcp_f32 v98, v97
    s_nop 0
    v_cmp_gt_u32 vcc, 32, v2
    v_pk_mul_f32 v[64:65], v[64:65], v[98:99] op_sel_hi:[1,0]
    v_pk_mul_f32 v[66:67], v[66:67], v[98:99] op_sel_hi:[1,0]
    v_pk_mul_f32 v[68:69], v[68:69], v[98:99] op_sel_hi:[1,0]
    v_pk_mul_f32 v[70:71], v[70:71], v[98:99] op_sel_hi:[1,0]
    v_pk_mul_f32 v[72:73], v[72:73], v[98:99] op_sel_hi:[1,0]
    v_pk_mul_f32 v[74:75], v[74:75], v[98:99] op_sel_hi:[1,0]
    v_pk_mul_f32 v[76:77], v[76:77], v[98:99] op_sel_hi:[1,0]
    v_pk_mul_f32 v[78:79], v[78:79], v[98:99] op_sel_hi:[1,0]
    v_cvt_pk_bf16_f32 v40, v64, v65
    v_cvt_pk_bf16_f32 v41, v66, v67
    v_cvt_pk_bf16_f32 v42, v68, v69
    v_cvt_pk_bf16_f32 v43, v70, v71
    buffer_store_dwordx4 v[40:43], v3, s[36:39], s14 offen sc1
    v_cvt_pk_bf16_f32 v44, v72, v73
    v_cvt_pk_bf16_f32 v45, v74, v75
    v_cvt_pk_bf16_f32 v46, v76, v77
    v_cvt_pk_bf16_f32 v47, v78, v79
    v_cndmask_b32 v46, 0, v46, vcc
    v_cndmask_b32 v47, 0, v47, vcc
    buffer_store_dwordx4 v[44:47], v3, s[36:39], s14 offen offset:1024 sc1
    s_branch L_p3
L_code_end:
.section .rodata,"a"
.p2align 6
.amdhsa_kernel concat_heads__softmax_full_mha__mha_block__prompt_kernel
.amdhsa_next_free_vgpr 256
.amdhsa_next_free_sgpr 102
.amdhsa_accum_offset 256
.amdhsa_group_segment_fixed_size 0
.amdhsa_kernarg_size 72
.amdhsa_user_sgpr_count 2
.amdhsa_user_sgpr_kernarg_segment_ptr 1
.amdhsa_system_sgpr_workgroup_id_x 1
.end_amdhsa_kernel
.text
```
